```python
import torch

def _softmax(x, axis=-1):
    return torch.softmax(x, dim=axis)
def _gelu(x):
    return torch.nn.functional.gelu(x, approximate="tanh")
def _silu(x):
    return torch.nn.functional.silu(x)
def _sigmoid(x):
    return torch.sigmoid(x)
def _layernorm(x, axis=-1, eps=1e-5):
    m = x.mean(dim=axis, keepdim=True)
    v = x.var(dim=axis, keepdim=True, unbiased=False)
    return (x - m) / torch.sqrt(v + eps)
def _scatter_add(tgt, idx, src, axis=0):
    return tgt.clone().index_add_(axis, idx, src)
def _segment_sum(src, seg, n):
    out = torch.zeros((n,) + src.shape[1:], dtype=src.dtype)
    return out.index_add_(0, seg, src)
def _pad(x, pw):
    flat = tuple(v for pair in reversed(pw) for v in pair)
    return torch.nn.functional.pad(x, flat)

kernel_name = 'recurrent_scan__gqa_block_cached__glu_gated_geglu__decode'

def setup_inputs():

    _w = (lambda a: (lambda t: t.to(torch.bfloat16) if t.is_floating_point() else t)(torch.as_tensor(a)))
    def _A_setup():
        B, Sq, D = 2, 1, 512
        Hq, Hkv, Sk, Dh = 32, 8, 32768, 128
        assert Hq % Hkv == 0, (Hq, Hkv)
        return {
            "x": _w((lambda *s: torch.randn(*s, dtype=torch.bfloat16) * 0.4)(B, Sq, D)),
            "k_cache": _w((lambda *s: torch.randn(*s, dtype=torch.bfloat16) * 1.6)(B, Hkv, Sk, Dh)),
            "v_cache": _w((lambda *s: torch.randn(*s, dtype=torch.bfloat16) * 1.6)(B, Hkv, Sk, Dh)),
            "wq": _w((lambda *s: torch.randn(*s, dtype=torch.bfloat16) * 1.6)(D, Hq * Dh) * (D ** -0.5)),
            "wo": _w((lambda *s: torch.randn(*s, dtype=torch.bfloat16) * 1.6)(Hq * Dh, D) * ((Hq * Dh) ** -0.5)),
        }
    _A_in = _A_setup()

    def _B_setup():
        B, S, Dm, Df = 2, 1, 512, 1792
        return {
            "x": _w((lambda *s: torch.randn(*s, dtype=torch.bfloat16) * 0.4)(B, S, Dm)),
            "w_gate": _w((lambda *s: torch.randn(*s, dtype=torch.bfloat16) * 1.6)(Dm, Df) * (Dm ** -0.5)),
            "w_up": _w((lambda *s: torch.randn(*s, dtype=torch.bfloat16) * 1.6)(Dm, Df) * (Dm ** -0.5)),
            "w_down": _w((lambda *s: torch.randn(*s, dtype=torch.bfloat16) * 1.6)(Df, Dm) * (Df ** -0.5)),
        }
    _B_in = _B_setup()

    return {
        "A_x": _A_in["x"],
        "A_k_cache": _A_in["k_cache"],
        "A_v_cache": _A_in["v_cache"],
        "A_wq": _A_in["wq"],
        "A_wo": _A_in["wo"],
        "B_x": _B_in["x"],
        "B_w_gate": _B_in["w_gate"],
        "B_w_up": _B_in["w_up"],
        "B_w_down": _B_in["w_down"],
    }

def reference(A_x, A_k_cache, A_v_cache, A_wq, A_wo, B_x, B_w_gate, B_w_up, B_w_down):
    def _A_ref(x, k_cache, v_cache, wq, wo):
        B, Sq, D = x.shape
        Hq, Dh = 32, 128
        Hkv = k_cache.shape[1]
        rep = Hq // Hkv
        q = (lambda x, *d: x.permute(*d))((x @ wq).reshape(B, Sq, Hq, Dh), 0, 2, 1, 3)
        k = (lambda x, n, axis: torch.repeat_interleave(x, n, dim=axis))(k_cache, rep, axis=1)
        v = (lambda x, n, axis: torch.repeat_interleave(x, n, dim=axis))(v_cache, rep, axis=1)
        scores = torch.einsum("bhqd,bhkd->bhqk", q, k) * (Dh ** -0.5)
        p = _softmax(scores, axis=-1)
        o = torch.einsum("bhqk,bhkd->bhqd", p, v)
        return (lambda x, *d: x.permute(*d))(o, 0, 2, 1, 3).reshape(B, Sq, Hq * Dh) @ wo

    def _B_ref(x, w_gate, w_up, w_down):
        g = torch.einsum("bsd,df->bsf", x, w_gate)
        u = torch.einsum("bsd,df->bsf", x, w_up)
        h = _gelu(g) * u
        return torch.einsum("bsf,fd->bsd", h, w_down)

    x = A_x
    xn = _layernorm(x, axis=-1)
    s = _A_ref(xn, A_k_cache, A_v_cache, A_wq, A_wo)
    g = _silu(_B_ref(xn, B_w_gate, B_w_up, B_w_down))
    return x + s * g
```

```asm
; @launch grid=(256,1,1) block=(512,1,1) lds=50176
.amdgcn_target "amdgcn-amd-amdhsa--gfx950"
.text
.globl recurrent_scan__gqa_block_cached__glu_gated_geglu__decode_kernel
.p2align 8
.type recurrent_scan__gqa_block_cached__glu_gated_geglu__decode_kernel,@function
recurrent_scan__gqa_block_cached__glu_gated_geglu__decode_kernel:
  s_cmp_ge_u32 s2, 256
  s_cbranch_scc1 L_exit
  s_load_dwordx16 s[16:31], s[0:1], 0
  s_load_dwordx8 s[32:39], s[0:1], 64
  v_lshrrev_b32 v1, 6, v0
  v_and_b32 v0, 63, v0
  v_readfirstlane_b32 s3, v1
  s_lshr_b32 s6, s2, 7
  s_and_b32 s7, s2, 7
  s_bfe_u32 s5, s2, 0x40003
  s_cmp_ge_u32 s3, 4
  s_cbranch_scc1 L_helper
  v_and_b32 v5, 1, v0
  v_lshlrev_b32 v5, 4, v5
  v_bfe_u32 v6, v0, 1, 1
  v_lshl_add_u32 v5, v6, 10, v5
  v_bfe_u32 v6, v0, 2, 2
  v_lshl_add_u32 v5, v6, 8, v5
  v_lshrrev_b32 v6, 4, v0
  v_lshl_add_u32 v1, v6, 5, v5
  v_add_u32 v2, 128, v1
  s_lshl_b32 s62, s6, 3
  s_add_u32 s62, s62, s7
  s_lshl_b32 s62, s62, 23
  s_bfe_u32 s61, s5, 262144
  s_lshl_b32 s61, s61, 15
  s_add_u32 s62, s62, s61
  s_bfe_u32 s61, s3, 131072
  s_lshl_b32 s61, s61, 12
  s_add_u32 s62, s62, s61
  s_add_u32 s63, s62, 16384
  s_add_u32 s64, s62, 524288
  s_add_u32 s65, s63, 524288
  s_mov_b32 s10, 134217728
  s_mov_b32 s11, 0x20000
  s_waitcnt lgkmcnt(0)
  s_mov_b32 s8, s18
  s_and_b32 s9, s19, 0xffff
  buffer_load_dwordx4 v[64:67], v1, s[8:11], s62 offen offset:0 nt
  buffer_load_dwordx4 v[96:99], v1, s[8:11], s64 offen offset:0 nt
  buffer_load_dwordx4 v[80:83], v1, s[8:11], s63 offen offset:0 nt
  buffer_load_dwordx4 v[112:115], v1, s[8:11], s65 offen offset:0 nt
  s_barrier
  buffer_load_dwordx4 v[68:71], v2, s[8:11], s62 offen offset:0 nt
  buffer_load_dwordx4 v[84:87], v2, s[8:11], s63 offen offset:0 nt
  s_waitcnt vmcnt(5)
  s_mov_b32 s50, 0x05040100
  s_mov_b32 s51, 0x07060302
  buffer_load_dwordx4 v[100:103], v2, s[8:11], s64 offen offset:0 nt
  s_waitcnt vmcnt(5)
  v_mov_b32 v3, 0xff7fffff
  s_mov_b32 s52, 0x3db504f3
  s_mov_b32 s53, 0x3fb8aa3b
  buffer_load_dwordx4 v[116:119], v2, s[8:11], s65 offen offset:0 nt
  s_waitcnt vmcnt(5)
  v_and_b32 v7, 3, v0
  v_sub_u32 v8, 3, v7
  s_mov_b32 s66, 0xf0f0f0f0
  buffer_load_dwordx4 v[72:75], v1, s[8:11], s62 offen offset:2048 nt
  s_waitcnt vmcnt(5)
  s_mov_b32 s67, 0xf0f0f0f0
  v_cndmask_b32 v8, v7, v8, s[66:67]
  v_lshlrev_b32 v8, 8, v8
  buffer_load_dwordx4 v[76:79], v2, s[8:11], s62 offen offset:2048 nt
  s_waitcnt vmcnt(5)
  v_lshl_add_u32 v8, v6, 5, v8
  v_bfe_u32 v9, v0, 3, 1
  v_lshl_add_u32 v8, v9, 4, v8
  buffer_load_dwordx4 v[88:91], v1, s[8:11], s63 offen offset:2048 nt
  s_waitcnt vmcnt(5)
  v_mov_b32 v16, 0
  v_mov_b32 v17, 0
  v_mov_b32 v18, 0
  buffer_load_dwordx4 v[92:95], v2, s[8:11], s63 offen offset:2048 nt
  s_waitcnt vmcnt(5)
  v_mov_b32 v19, 0
  v_mov_b32 v20, 0
  v_mov_b32 v21, 0
  buffer_load_dwordx4 v[104:107], v1, s[8:11], s64 offen offset:2048 nt
  s_waitcnt vmcnt(5)
  v_mov_b32 v22, 0
  v_mov_b32 v23, 0
  v_mov_b32 v24, 0
  buffer_load_dwordx4 v[108:111], v2, s[8:11], s64 offen offset:2048 nt
  s_waitcnt vmcnt(5)
  v_mov_b32 v25, 0
  v_mov_b32 v26, 0
  buffer_load_dwordx4 v[120:123], v1, s[8:11], s65 offen offset:2048 nt
  s_waitcnt vmcnt(5)
  v_mov_b32 v27, 0
  v_mov_b32 v28, 0
  v_mov_b32 v29, 0
  buffer_load_dwordx4 v[124:127], v2, s[8:11], s65 offen offset:2048 nt
  s_waitcnt vmcnt(5)
  v_mov_b32 v30, 0
  v_mov_b32 v31, 0
  s_mul_i32 s58, s3, 2112
  s_add_u32 s62, s62, 1048576
  s_add_u32 s63, s63, 1048576
  s_add_u32 s64, s64, 1048576
  s_add_u32 s65, s65, 1048576
  buffer_load_dwordx4 v[128:131], v1, s[8:11], s62 offen offset:0 nt
  s_waitcnt vmcnt(5)
  s_add_u32 s58, s58, 8192
  v_mul_u32_u24 v5, 528, v7
  v_lshl_add_u32 v5, v6, 7, v5
  buffer_load_dwordx4 v[132:135], v2, s[8:11], s62 offen offset:0 nt
  s_waitcnt vmcnt(5)
  v_add_u32 v5, s58, v5
  s_lshl_b32 s58, s3, 2
  s_add_u32 s58, s58, 16896
  buffer_load_dwordx4 v[136:139], v1, s[8:11], s62 offen offset:2048 nt
  s_waitcnt vmcnt(5)
  v_lshl_add_u32 v6, v7, 4, s58
  s_lshl_b32 s58, s3, 13
  s_add_u32 s58, s58, 17408
  buffer_load_dwordx4 v[140:143], v2, s[8:11], s62 offen offset:2048 nt
  s_waitcnt vmcnt(5)
  v_lshl_add_u32 v4, v0, 3, s58
  v_lshlrev_b32 v63, 4, v0
  v_mov_b32 v0, 6160
  buffer_load_dwordx4 v[144:147], v1, s[8:11], s63 offen offset:0 nt
  s_waitcnt vmcnt(5)
  s_mov_b32 s61, 0
  s_mov_b32 s56, 0x000f000f
  s_mov_b32 s57, 0x000f000f
  buffer_load_dwordx4 v[148:151], v2, s[8:11], s63 offen offset:0 nt
  s_waitcnt vmcnt(5)
  buffer_load_dwordx4 v[152:155], v1, s[8:11], s63 offen offset:2048 nt
  s_waitcnt vmcnt(5)
  buffer_load_dwordx4 v[156:159], v2, s[8:11], s63 offen offset:2048 nt
  s_waitcnt vmcnt(5)
  buffer_load_dwordx4 v[160:163], v1, s[8:11], s64 offen offset:0 nt
  s_waitcnt vmcnt(5)
  buffer_load_dwordx4 v[164:167], v2, s[8:11], s64 offen offset:0 nt
  s_waitcnt vmcnt(5)
  buffer_load_dwordx4 v[168:171], v1, s[8:11], s64 offen offset:2048 nt
  s_waitcnt vmcnt(5)
  buffer_load_dwordx4 v[172:175], v2, s[8:11], s64 offen offset:2048 nt
  s_waitcnt vmcnt(5)
  buffer_load_dwordx4 v[176:179], v1, s[8:11], s65 offen offset:0 nt
  s_waitcnt vmcnt(5)
  buffer_load_dwordx4 v[180:183], v2, s[8:11], s65 offen offset:0 nt
  s_waitcnt vmcnt(5)
  buffer_load_dwordx4 v[184:187], v1, s[8:11], s65 offen offset:2048 nt
  s_waitcnt vmcnt(5)
  ds_read_b32 v9, v0 offset:8
  buffer_load_dwordx4 v[188:191], v2, s[8:11], s65 offen offset:2048 nt
  s_waitcnt vmcnt(5)
  s_add_u32 s62, s62, 1048576
  s_add_u32 s63, s63, 1048576
  s_add_u32 s64, s64, 1048576
  s_add_u32 s65, s65, 1048576
  s_waitcnt lgkmcnt(0)
  v_readfirstlane_b32 s58, v9
  s_nop 0
  s_cmp_lt_u32 s58, 4
  s_cbranch_scc1 L_slowq
  s_not_b64 exec, s[66:67]
  ds_read_b128 v[16:19], v8 offset:0
  ds_read_b128 v[20:23], v8 offset:128
  s_mov_b64 exec, s[66:67]
  ds_read_b128 v[24:27], v8 offset:0
  ds_read_b128 v[28:31], v8 offset:128
  s_mov_b64 exec, -1
  s_waitcnt lgkmcnt(0)
  s_branch L_KN0
L_slowq:
  buffer_load_dwordx4 v[192:195], v1, s[8:11], s62 offen offset:0 nt
  s_waitcnt vmcnt(5)
  buffer_load_dwordx4 v[196:199], v2, s[8:11], s62 offen offset:0 nt
  s_waitcnt vmcnt(5)
  buffer_load_dwordx4 v[200:203], v1, s[8:11], s62 offen offset:2048 nt
  s_waitcnt vmcnt(5)
  buffer_load_dwordx4 v[204:207], v2, s[8:11], s62 offen offset:2048 nt
  s_waitcnt vmcnt(5)
  buffer_load_dwordx4 v[208:211], v1, s[8:11], s63 offen offset:0 nt
  s_waitcnt vmcnt(5)
  buffer_load_dwordx4 v[212:215], v2, s[8:11], s63 offen offset:0 nt
  s_waitcnt vmcnt(5)
  buffer_load_dwordx4 v[216:219], v1, s[8:11], s63 offen offset:2048 nt
  s_waitcnt vmcnt(5)
  buffer_load_dwordx4 v[220:223], v2, s[8:11], s63 offen offset:2048 nt
  s_waitcnt vmcnt(5)
  buffer_load_dwordx4 v[224:227], v1, s[8:11], s64 offen offset:0 nt
  s_waitcnt vmcnt(5)
  buffer_load_dwordx4 v[228:231], v2, s[8:11], s64 offen offset:0 nt
  s_waitcnt vmcnt(5)
  buffer_load_dwordx4 v[232:235], v1, s[8:11], s64 offen offset:2048 nt
  s_waitcnt vmcnt(5)
  buffer_load_dwordx4 v[236:239], v2, s[8:11], s64 offen offset:2048 nt
  s_waitcnt vmcnt(5)
  buffer_load_dwordx4 v[240:243], v1, s[8:11], s65 offen offset:0 nt
  s_waitcnt vmcnt(5)
  buffer_load_dwordx4 v[244:247], v2, s[8:11], s65 offen offset:0 nt
  s_waitcnt vmcnt(5)
  buffer_load_dwordx4 v[248:251], v1, s[8:11], s65 offen offset:2048 nt
  s_waitcnt vmcnt(5)
  buffer_load_dwordx4 v[252:255], v2, s[8:11], s65 offen offset:2048 nt
  s_add_u32 s62, s62, 1048576
  s_add_u32 s63, s63, 1048576
  s_add_u32 s64, s64, 1048576
  s_add_u32 s65, s65, 1048576
  s_mov_b64 exec, 1
  v_mov_b32 v7, 2
  ds_add_u32 v0, v7 offset:96
  s_mov_b64 exec, -1
  s_mov_b32 s68, 8000000
L_qw:
  ds_read_b32 v9, v0 offset:8
  s_sub_u32 s68, s68, 1
  s_cbranch_scc1 L_qx
  s_waitcnt lgkmcnt(0)
  v_readfirstlane_b32 s58, v9
  s_nop 0
  s_cmp_lt_u32 s58, 4
  s_cbranch_scc1 L_qw
L_qx:
  s_not_b64 exec, s[66:67]
  ds_read_b128 v[16:19], v8 offset:0
  ds_read_b128 v[20:23], v8 offset:128
  s_mov_b64 exec, s[66:67]
  ds_read_b128 v[24:27], v8 offset:0
  ds_read_b128 v[28:31], v8 offset:128
  s_mov_b64 exec, -1
  s_waitcnt lgkmcnt(0)
  s_waitcnt vmcnt(32)
  v_mfma_f32_16x16x32_bf16 v[8:11], v[64:67], v[16:19], 0
  v_mfma_f32_16x16x32_bf16 v[12:15], v[72:75], v[16:19], 0
  v_mfma_f32_16x16x32_bf16 v[8:11], v[68:71], v[20:23], v[8:11]
  v_mfma_f32_16x16x32_bf16 v[12:15], v[76:79], v[20:23], v[12:15]
  v_mfma_f32_16x16x32_bf16 v[8:11], v[80:83], v[24:27], v[8:11]
  v_mfma_f32_16x16x32_bf16 v[12:15], v[88:91], v[24:27], v[12:15]
  v_mfma_f32_16x16x32_bf16 v[8:11], v[84:87], v[28:31], v[8:11]
  v_mfma_f32_16x16x32_bf16 v[12:15], v[92:95], v[28:31], v[12:15]
  v_mfma_f32_16x16x32_bf16 v[32:35], v[96:99], v[16:19], 0
  v_mfma_f32_16x16x32_bf16 v[36:39], v[104:107], v[16:19], 0
  v_mfma_f32_16x16x32_bf16 v[32:35], v[100:103], v[20:23], v[32:35]
  v_mfma_f32_16x16x32_bf16 v[36:39], v[108:111], v[20:23], v[36:39]
  v_mfma_f32_16x16x32_bf16 v[32:35], v[112:115], v[24:27], v[32:35]
  v_mfma_f32_16x16x32_bf16 v[36:39], v[120:123], v[24:27], v[36:39]
  v_mfma_f32_16x16x32_bf16 v[32:35], v[116:119], v[28:31], v[32:35]
  v_mfma_f32_16x16x32_bf16 v[36:39], v[124:127], v[28:31], v[36:39]
  v_add_f32_dpp v8, v9, v8 row_ror:8 row_mask:0xf bank_mask:0xf
  v_add_f32_dpp v10, v11, v10 row_ror:8 row_mask:0xf bank_mask:0xf
  v_add_f32_dpp v12, v13, v12 row_ror:8 row_mask:0xf bank_mask:0xf
  v_add_f32_dpp v14, v15, v14 row_ror:8 row_mask:0xf bank_mask:0xf
  v_cvt_pk_bf16_f32 v40, v8, v10
  v_cvt_pk_bf16_f32 v41, v12, v14
  v_lshlrev_b32 v8, 16, v40
  v_and_b32 v10, 0xffff0000, v40
  v_lshlrev_b32 v12, 16, v41
  v_and_b32 v14, 0xffff0000, v41
  v_mul_f32 v8, s52, v8
  v_mul_f32 v10, s52, v10
  v_mul_f32 v12, s52, v12
  v_mul_f32 v14, s52, v14
  v_cvt_pk_bf16_f32 v44, v8, v10
  v_cvt_pk_bf16_f32 v45, v12, v14
  v_max3_f32 v3, v3, v8, v10
  v_max3_f32 v3, v3, v12, v14
  ds_write_b64 v4, v[44:45] offset:0
  v_add_f32_dpp v32, v33, v32 row_ror:8 row_mask:0xf bank_mask:0xf
  v_add_f32_dpp v34, v35, v34 row_ror:8 row_mask:0xf bank_mask:0xf
  v_add_f32_dpp v36, v37, v36 row_ror:8 row_mask:0xf bank_mask:0xf
  v_add_f32_dpp v38, v39, v38 row_ror:8 row_mask:0xf bank_mask:0xf
  v_cvt_pk_bf16_f32 v42, v32, v34
  v_cvt_pk_bf16_f32 v43, v36, v38
  v_lshlrev_b32 v32, 16, v42
  v_and_b32 v34, 0xffff0000, v42
  v_lshlrev_b32 v36, 16, v43
  v_and_b32 v38, 0xffff0000, v43
  v_mul_f32 v32, s52, v32
  v_mul_f32 v34, s52, v34
  v_mul_f32 v36, s52, v36
  v_mul_f32 v38, s52, v38
  v_cvt_pk_bf16_f32 v46, v32, v34
  v_cvt_pk_bf16_f32 v47, v36, v38
  v_max3_f32 v3, v3, v32, v34
  v_max3_f32 v3, v3, v36, v38
  ds_write_b64 v4, v[46:47] offset:512
  v_add_u32 v4, 1024, v4
  s_add_u32 s61, s61, 1
L_KN1:
  s_waitcnt vmcnt(5)
  buffer_load_dwordx4 v[64:67], v1, s[8:11], s62 offen offset:0 nt
  v_mfma_f32_16x16x32_bf16 v[8:11], v[128:131], v[16:19], 0
  v_mfma_f32_16x16x32_bf16 v[12:15], v[136:139], v[16:19], 0
  v_mfma_f32_16x16x32_bf16 v[8:11], v[132:135], v[20:23], v[8:11]
  s_waitcnt vmcnt(5)
  buffer_load_dwordx4 v[68:71], v2, s[8:11], s62 offen offset:0 nt
  v_mfma_f32_16x16x32_bf16 v[12:15], v[140:143], v[20:23], v[12:15]
  v_mfma_f32_16x16x32_bf16 v[8:11], v[144:147], v[24:27], v[8:11]
  v_mfma_f32_16x16x32_bf16 v[12:15], v[152:155], v[24:27], v[12:15]
  s_waitcnt vmcnt(5)
  buffer_load_dwordx4 v[72:75], v1, s[8:11], s62 offen offset:2048 nt
  v_mfma_f32_16x16x32_bf16 v[8:11], v[148:151], v[28:31], v[8:11]
  v_mfma_f32_16x16x32_bf16 v[12:15], v[156:159], v[28:31], v[12:15]
  v_mfma_f32_16x16x32_bf16 v[32:35], v[160:163], v[16:19], 0
  v_mfma_f32_16x16x32_bf16 v[36:39], v[168:171], v[16:19], 0
  s_waitcnt vmcnt(5)
  buffer_load_dwordx4 v[76:79], v2, s[8:11], s62 offen offset:2048 nt
  v_mfma_f32_16x16x32_bf16 v[32:35], v[164:167], v[20:23], v[32:35]
  v_mfma_f32_16x16x32_bf16 v[36:39], v[172:175], v[20:23], v[36:39]
  v_mfma_f32_16x16x32_bf16 v[32:35], v[176:179], v[24:27], v[32:35]
  s_waitcnt vmcnt(5)
  buffer_load_dwordx4 v[80:83], v1, s[8:11], s63 offen offset:0 nt
  v_mfma_f32_16x16x32_bf16 v[36:39], v[184:187], v[24:27], v[36:39]
  v_mfma_f32_16x16x32_bf16 v[32:35], v[180:183], v[28:31], v[32:35]
  v_mfma_f32_16x16x32_bf16 v[36:39], v[188:191], v[28:31], v[36:39]
  v_add_f32_dpp v8, v9, v8 row_ror:8 row_mask:0xf bank_mask:0xf
  s_waitcnt vmcnt(5)
  buffer_load_dwordx4 v[84:87], v2, s[8:11], s63 offen offset:0 nt
  v_add_f32_dpp v10, v11, v10 row_ror:8 row_mask:0xf bank_mask:0xf
  v_add_f32_dpp v12, v13, v12 row_ror:8 row_mask:0xf bank_mask:0xf
  v_add_f32_dpp v14, v15, v14 row_ror:8 row_mask:0xf bank_mask:0xf
  s_waitcnt vmcnt(5)
  buffer_load_dwordx4 v[88:91], v1, s[8:11], s63 offen offset:2048 nt
  v_cvt_pk_bf16_f32 v40, v8, v10
  v_cvt_pk_bf16_f32 v41, v12, v14
  v_lshlrev_b32 v8, 16, v40
  v_and_b32 v10, 0xffff0000, v40
  s_waitcnt vmcnt(5)
  buffer_load_dwordx4 v[92:95], v2, s[8:11], s63 offen offset:2048 nt
  s_mov_b64 exec, 1
  v_mov_b32 v49, 1
  ds_add_u32 v0, v49 offset:96
  s_mov_b64 exec, -1
  v_lshlrev_b32 v12, 16, v41
  v_and_b32 v14, 0xffff0000, v41
  v_mul_f32 v8, s52, v8
  s_waitcnt vmcnt(5)
  buffer_load_dwordx4 v[96:99], v1, s[8:11], s64 offen offset:0 nt
  v_mul_f32 v10, s52, v10
  v_mul_f32 v12, s52, v12
  v_mul_f32 v14, s52, v14
  s_waitcnt vmcnt(5)
  buffer_load_dwordx4 v[100:103], v2, s[8:11], s64 offen offset:0 nt
  v_cvt_pk_bf16_f32 v44, v8, v10
  v_cvt_pk_bf16_f32 v45, v12, v14
  v_max3_f32 v3, v3, v8, v10
  v_max3_f32 v3, v3, v12, v14
  s_waitcnt vmcnt(5)
  buffer_load_dwordx4 v[104:107], v1, s[8:11], s64 offen offset:2048 nt
  ds_write_b64 v4, v[44:45] offset:0
  v_add_f32_dpp v32, v33, v32 row_ror:8 row_mask:0xf bank_mask:0xf
  v_add_f32_dpp v34, v35, v34 row_ror:8 row_mask:0xf bank_mask:0xf
  s_waitcnt vmcnt(5)
  buffer_load_dwordx4 v[108:111], v2, s[8:11], s64 offen offset:2048 nt
  v_add_f32_dpp v36, v37, v36 row_ror:8 row_mask:0xf bank_mask:0xf
  v_add_f32_dpp v38, v39, v38 row_ror:8 row_mask:0xf bank_mask:0xf
  v_cvt_pk_bf16_f32 v42, v32, v34
  v_cvt_pk_bf16_f32 v43, v36, v38
  s_waitcnt vmcnt(5)
  buffer_load_dwordx4 v[112:115], v1, s[8:11], s65 offen offset:0 nt
  v_lshlrev_b32 v32, 16, v42
  v_and_b32 v34, 0xffff0000, v42
  v_lshlrev_b32 v36, 16, v43
  s_waitcnt vmcnt(5)
  buffer_load_dwordx4 v[116:119], v2, s[8:11], s65 offen offset:0 nt
  v_and_b32 v38, 0xffff0000, v43
  v_mul_f32 v32, s52, v32
  v_mul_f32 v34, s52, v34
  v_mul_f32 v36, s52, v36
  s_waitcnt vmcnt(5)
  buffer_load_dwordx4 v[120:123], v1, s[8:11], s65 offen offset:2048 nt
  v_mul_f32 v38, s52, v38
  v_cvt_pk_bf16_f32 v46, v32, v34
  v_cvt_pk_bf16_f32 v47, v36, v38
  s_waitcnt vmcnt(5)
  buffer_load_dwordx4 v[124:127], v2, s[8:11], s65 offen offset:2048 nt
  s_mov_b64 exec, 1
  v_mov_b32 v49, 1
  ds_add_u32 v0, v49 offset:96
  s_mov_b64 exec, -1
  ds_read_b32 v48, v0 offset:4
  v_max3_f32 v3, v3, v32, v34
  v_max3_f32 v3, v3, v36, v38
  ds_write_b64 v4, v[46:47] offset:512
  v_add_u32 v4, 1024, v4
  s_add_u32 s62, s62, 1048576
  s_add_u32 s63, s63, 1048576
  s_add_u32 s64, s64, 1048576
  s_add_u32 s65, s65, 1048576
  s_add_u32 s61, s61, 1
  s_waitcnt lgkmcnt(0)
  v_readfirstlane_b32 s66, v48
  s_cmp_eq_u32 s61, 8
  s_cbranch_scc1 L_trans
  s_lshl_b32 s67, s61, 5
  s_cmp_eq_u32 s66, 0
  s_cselect_b32 s66, s67, s66
  s_sub_i32 s66, s66, s67
  s_cmp_ge_i32 s66, 8
  s_cbranch_scc1 L_KB2
  s_cmp_lt_i32 s66, -6
  s_cbranch_scc1 L_KS2
L_KN2:
  s_waitcnt vmcnt(5)
  buffer_load_dwordx4 v[128:131], v1, s[8:11], s62 offen offset:0 nt
  v_mfma_f32_16x16x32_bf16 v[8:11], v[192:195], v[16:19], 0
  v_mfma_f32_16x16x32_bf16 v[12:15], v[200:203], v[16:19], 0
  v_mfma_f32_16x16x32_bf16 v[8:11], v[196:199], v[20:23], v[8:11]
  s_waitcnt vmcnt(5)
  buffer_load_dwordx4 v[132:135], v2, s[8:11], s62 offen offset:0 nt
  v_mfma_f32_16x16x32_bf16 v[12:15], v[204:207], v[20:23], v[12:15]
  v_mfma_f32_16x16x32_bf16 v[8:11], v[208:211], v[24:27], v[8:11]
  v_mfma_f32_16x16x32_bf16 v[12:15], v[216:219], v[24:27], v[12:15]
  s_waitcnt vmcnt(5)
  buffer_load_dwordx4 v[136:139], v1, s[8:11], s62 offen offset:2048 nt
  v_mfma_f32_16x16x32_bf16 v[8:11], v[212:215], v[28:31], v[8:11]
  v_mfma_f32_16x16x32_bf16 v[12:15], v[220:223], v[28:31], v[12:15]
  v_mfma_f32_16x16x32_bf16 v[32:35], v[224:227], v[16:19], 0
  v_mfma_f32_16x16x32_bf16 v[36:39], v[232:235], v[16:19], 0
  s_waitcnt vmcnt(5)
  buffer_load_dwordx4 v[140:143], v2, s[8:11], s62 offen offset:2048 nt
  v_mfma_f32_16x16x32_bf16 v[32:35], v[228:231], v[20:23], v[32:35]
  v_mfma_f32_16x16x32_bf16 v[36:39], v[236:239], v[20:23], v[36:39]
  v_mfma_f32_16x16x32_bf16 v[32:35], v[240:243], v[24:27], v[32:35]
  s_waitcnt vmcnt(5)
  buffer_load_dwordx4 v[144:147], v1, s[8:11], s63 offen offset:0 nt
  v_mfma_f32_16x16x32_bf16 v[36:39], v[248:251], v[24:27], v[36:39]
  v_mfma_f32_16x16x32_bf16 v[32:35], v[244:247], v[28:31], v[32:35]
  v_mfma_f32_16x16x32_bf16 v[36:39], v[252:255], v[28:31], v[36:39]
  v_add_f32_dpp v8, v9, v8 row_ror:8 row_mask:0xf bank_mask:0xf
  s_waitcnt vmcnt(5)
  buffer_load_dwordx4 v[148:151], v2, s[8:11], s63 offen offset:0 nt
  v_add_f32_dpp v10, v11, v10 row_ror:8 row_mask:0xf bank_mask:0xf
  v_add_f32_dpp v12, v13, v12 row_ror:8 row_mask:0xf bank_mask:0xf
  v_add_f32_dpp v14, v15, v14 row_ror:8 row_mask:0xf bank_mask:0xf
  s_waitcnt vmcnt(5)
  buffer_load_dwordx4 v[152:155], v1, s[8:11], s63 offen offset:2048 nt
  v_cvt_pk_bf16_f32 v40, v8, v10
  v_cvt_pk_bf16_f32 v41, v12, v14
  v_lshlrev_b32 v8, 16, v40
  v_and_b32 v10, 0xffff0000, v40
  s_waitcnt vmcnt(5)
  buffer_load_dwordx4 v[156:159], v2, s[8:11], s63 offen offset:2048 nt
  s_mov_b64 exec, 1
  v_mov_b32 v49, 1
  ds_add_u32 v0, v49 offset:96
  s_mov_b64 exec, -1
  v_lshlrev_b32 v12, 16, v41
  v_and_b32 v14, 0xffff0000, v41
  v_mul_f32 v8, s52, v8
  s_waitcnt vmcnt(5)
  buffer_load_dwordx4 v[160:163], v1, s[8:11], s64 offen offset:0 nt
  v_mul_f32 v10, s52, v10
  v_mul_f32 v12, s52, v12
  v_mul_f32 v14, s52, v14
  s_waitcnt vmcnt(5)
  buffer_load_dwordx4 v[164:167], v2, s[8:11], s64 offen offset:0 nt
  v_cvt_pk_bf16_f32 v44, v8, v10
  v_cvt_pk_bf16_f32 v45, v12, v14
  v_max3_f32 v3, v3, v8, v10
  v_max3_f32 v3, v3, v12, v14
  s_waitcnt vmcnt(5)
  buffer_load_dwordx4 v[168:171], v1, s[8:11], s64 offen offset:2048 nt
  ds_write_b64 v4, v[44:45] offset:0
  v_add_f32_dpp v32, v33, v32 row_ror:8 row_mask:0xf bank_mask:0xf
  v_add_f32_dpp v34, v35, v34 row_ror:8 row_mask:0xf bank_mask:0xf
  s_waitcnt vmcnt(5)
  buffer_load_dwordx4 v[172:175], v2, s[8:11], s64 offen offset:2048 nt
  v_add_f32_dpp v36, v37, v36 row_ror:8 row_mask:0xf bank_mask:0xf
  v_add_f32_dpp v38, v39, v38 row_ror:8 row_mask:0xf bank_mask:0xf
  v_cvt_pk_bf16_f32 v42, v32, v34
  v_cvt_pk_bf16_f32 v43, v36, v38
  s_waitcnt vmcnt(5)
  buffer_load_dwordx4 v[176:179], v1, s[8:11], s65 offen offset:0 nt
  v_lshlrev_b32 v32, 16, v42
  v_and_b32 v34, 0xffff0000, v42
  v_lshlrev_b32 v36, 16, v43
  s_waitcnt vmcnt(5)
  buffer_load_dwordx4 v[180:183], v2, s[8:11], s65 offen offset:0 nt
  v_and_b32 v38, 0xffff0000, v43
  v_mul_f32 v32, s52, v32
  v_mul_f32 v34, s52, v34
  v_mul_f32 v36, s52, v36
  s_waitcnt vmcnt(5)
  buffer_load_dwordx4 v[184:187], v1, s[8:11], s65 offen offset:2048 nt
  v_mul_f32 v38, s52, v38
  v_cvt_pk_bf16_f32 v46, v32, v34
  v_cvt_pk_bf16_f32 v47, v36, v38
  s_waitcnt vmcnt(5)
  buffer_load_dwordx4 v[188:191], v2, s[8:11], s65 offen offset:2048 nt
  s_mov_b64 exec, 1
  v_mov_b32 v49, 1
  ds_add_u32 v0, v49 offset:96
  s_mov_b64 exec, -1
  ds_read_b32 v48, v0 offset:4
  v_max3_f32 v3, v3, v32, v34
  v_max3_f32 v3, v3, v36, v38
  ds_write_b64 v4, v[46:47] offset:512
  v_add_u32 v4, 1024, v4
  s_add_u32 s62, s62, 1048576
  s_add_u32 s63, s63, 1048576
  s_add_u32 s64, s64, 1048576
  s_add_u32 s65, s65, 1048576
  s_add_u32 s61, s61, 1
  s_cmp_lg_u32 s61, 6
  s_cbranch_scc1 L_nswN
  s_add_u32 s62, s62, 4286578688
  s_add_u32 s63, s63, 4286578688
  s_add_u32 s64, s64, 4286578688
  s_add_u32 s65, s65, 4286578688
  s_mov_b32 s8, s20
  s_and_b32 s9, s21, 0xffff
  v_mov_b32 v1, v63
  v_add_u32 v2, 1024, v63
L_nswN:
  s_waitcnt lgkmcnt(0)
  v_readfirstlane_b32 s66, v48
  s_lshl_b32 s67, s61, 5
  s_cmp_eq_u32 s66, 0
  s_cselect_b32 s66, s67, s66
  s_sub_i32 s66, s66, s67
  s_cmp_ge_i32 s66, 8
  s_cbranch_scc1 L_KB0
  s_cmp_lt_i32 s66, -6
  s_cbranch_scc1 L_KS0
L_KN0:
  s_waitcnt vmcnt(5)
  buffer_load_dwordx4 v[192:195], v1, s[8:11], s62 offen offset:0 nt
  v_mfma_f32_16x16x32_bf16 v[8:11], v[64:67], v[16:19], 0
  v_mfma_f32_16x16x32_bf16 v[12:15], v[72:75], v[16:19], 0
  v_mfma_f32_16x16x32_bf16 v[8:11], v[68:71], v[20:23], v[8:11]
  s_waitcnt vmcnt(5)
  buffer_load_dwordx4 v[196:199], v2, s[8:11], s62 offen offset:0 nt
  v_mfma_f32_16x16x32_bf16 v[12:15], v[76:79], v[20:23], v[12:15]
  v_mfma_f32_16x16x32_bf16 v[8:11], v[80:83], v[24:27], v[8:11]
  v_mfma_f32_16x16x32_bf16 v[12:15], v[88:91], v[24:27], v[12:15]
  s_waitcnt vmcnt(5)
  buffer_load_dwordx4 v[200:203], v1, s[8:11], s62 offen offset:2048 nt
  v_mfma_f32_16x16x32_bf16 v[8:11], v[84:87], v[28:31], v[8:11]
  v_mfma_f32_16x16x32_bf16 v[12:15], v[92:95], v[28:31], v[12:15]
  v_mfma_f32_16x16x32_bf16 v[32:35], v[96:99], v[16:19], 0
  v_mfma_f32_16x16x32_bf16 v[36:39], v[104:107], v[16:19], 0
  s_waitcnt vmcnt(5)
  buffer_load_dwordx4 v[204:207], v2, s[8:11], s62 offen offset:2048 nt
  v_mfma_f32_16x16x32_bf16 v[32:35], v[100:103], v[20:23], v[32:35]
  v_mfma_f32_16x16x32_bf16 v[36:39], v[108:111], v[20:23], v[36:39]
  v_mfma_f32_16x16x32_bf16 v[32:35], v[112:115], v[24:27], v[32:35]
  s_waitcnt vmcnt(5)
  buffer_load_dwordx4 v[208:211], v1, s[8:11], s63 offen offset:0 nt
  v_mfma_f32_16x16x32_bf16 v[36:39], v[120:123], v[24:27], v[36:39]
  v_mfma_f32_16x16x32_bf16 v[32:35], v[116:119], v[28:31], v[32:35]
  v_mfma_f32_16x16x32_bf16 v[36:39], v[124:127], v[28:31], v[36:39]
  v_add_f32_dpp v8, v9, v8 row_ror:8 row_mask:0xf bank_mask:0xf
  s_waitcnt vmcnt(5)
  buffer_load_dwordx4 v[212:215], v2, s[8:11], s63 offen offset:0 nt
  v_add_f32_dpp v10, v11, v10 row_ror:8 row_mask:0xf bank_mask:0xf
  v_add_f32_dpp v12, v13, v12 row_ror:8 row_mask:0xf bank_mask:0xf
  v_add_f32_dpp v14, v15, v14 row_ror:8 row_mask:0xf bank_mask:0xf
  s_waitcnt vmcnt(5)
  buffer_load_dwordx4 v[216:219], v1, s[8:11], s63 offen offset:2048 nt
  v_cvt_pk_bf16_f32 v40, v8, v10
  v_cvt_pk_bf16_f32 v41, v12, v14
  v_lshlrev_b32 v8, 16, v40
  v_and_b32 v10, 0xffff0000, v40
  s_waitcnt vmcnt(5)
  buffer_load_dwordx4 v[220:223], v2, s[8:11], s63 offen offset:2048 nt
  s_mov_b64 exec, 1
  v_mov_b32 v49, 1
  ds_add_u32 v0, v49 offset:96
  s_mov_b64 exec, -1
  v_lshlrev_b32 v12, 16, v41
  v_and_b32 v14, 0xffff0000, v41
  v_mul_f32 v8, s52, v8
  s_waitcnt vmcnt(5)
  buffer_load_dwordx4 v[224:227], v1, s[8:11], s64 offen offset:0 nt
  v_mul_f32 v10, s52, v10
  v_mul_f32 v12, s52, v12
  v_mul_f32 v14, s52, v14
  s_waitcnt vmcnt(5)
  buffer_load_dwordx4 v[228:231], v2, s[8:11], s64 offen offset:0 nt
  v_cvt_pk_bf16_f32 v44, v8, v10
  v_cvt_pk_bf16_f32 v45, v12, v14
  v_max3_f32 v3, v3, v8, v10
  v_max3_f32 v3, v3, v12, v14
  s_waitcnt vmcnt(5)
  buffer_load_dwordx4 v[232:235], v1, s[8:11], s64 offen offset:2048 nt
  ds_write_b64 v4, v[44:45] offset:0
  v_add_f32_dpp v32, v33, v32 row_ror:8 row_mask:0xf bank_mask:0xf
  v_add_f32_dpp v34, v35, v34 row_ror:8 row_mask:0xf bank_mask:0xf
  s_waitcnt vmcnt(5)
  buffer_load_dwordx4 v[236:239], v2, s[8:11], s64 offen offset:2048 nt
  v_add_f32_dpp v36, v37, v36 row_ror:8 row_mask:0xf bank_mask:0xf
  v_add_f32_dpp v38, v39, v38 row_ror:8 row_mask:0xf bank_mask:0xf
  v_cvt_pk_bf16_f32 v42, v32, v34
  v_cvt_pk_bf16_f32 v43, v36, v38
  s_waitcnt vmcnt(5)
  buffer_load_dwordx4 v[240:243], v1, s[8:11], s65 offen offset:0 nt
  v_lshlrev_b32 v32, 16, v42
  v_and_b32 v34, 0xffff0000, v42
  v_lshlrev_b32 v36, 16, v43
  s_waitcnt vmcnt(5)
  buffer_load_dwordx4 v[244:247], v2, s[8:11], s65 offen offset:0 nt
  v_and_b32 v38, 0xffff0000, v43
  v_mul_f32 v32, s52, v32
  v_mul_f32 v34, s52, v34
  v_mul_f32 v36, s52, v36
  s_waitcnt vmcnt(5)
  buffer_load_dwordx4 v[248:251], v1, s[8:11], s65 offen offset:2048 nt
  v_mul_f32 v38, s52, v38
  v_cvt_pk_bf16_f32 v46, v32, v34
  v_cvt_pk_bf16_f32 v47, v36, v38
  s_waitcnt vmcnt(5)
  buffer_load_dwordx4 v[252:255], v2, s[8:11], s65 offen offset:2048 nt
  s_mov_b64 exec, 1
  v_mov_b32 v49, 1
  ds_add_u32 v0, v49 offset:96
  s_mov_b64 exec, -1
  ds_read_b32 v48, v0 offset:4
  v_max3_f32 v3, v3, v32, v34
  v_max3_f32 v3, v3, v36, v38
  ds_write_b64 v4, v[46:47] offset:512
  v_add_u32 v4, 1024, v4
  s_add_u32 s62, s62, 1048576
  s_add_u32 s63, s63, 1048576
  s_add_u32 s64, s64, 1048576
  s_add_u32 s65, s65, 1048576
  s_add_u32 s61, s61, 1
  s_waitcnt lgkmcnt(0)
  v_readfirstlane_b32 s66, v48
  s_lshl_b32 s67, s61, 5
  s_cmp_eq_u32 s66, 0
  s_cselect_b32 s66, s67, s66
  s_sub_i32 s66, s66, s67
  s_cmp_ge_i32 s66, 8
  s_cbranch_scc1 L_KB1
  s_cmp_lt_i32 s66, -6
  s_cbranch_scc1 L_KS1
  s_branch L_KN1
L_KB1:
  s_waitcnt vmcnt(7)
  buffer_load_dwordx4 v[64:67], v1, s[8:11], s62 offen offset:0 nt
  v_mfma_f32_16x16x32_bf16 v[8:11], v[128:131], v[16:19], 0
  v_mfma_f32_16x16x32_bf16 v[12:15], v[136:139], v[16:19], 0
  v_mfma_f32_16x16x32_bf16 v[8:11], v[132:135], v[20:23], v[8:11]
  s_waitcnt vmcnt(7)
  buffer_load_dwordx4 v[68:71], v2, s[8:11], s62 offen offset:0 nt
  v_mfma_f32_16x16x32_bf16 v[12:15], v[140:143], v[20:23], v[12:15]
  v_mfma_f32_16x16x32_bf16 v[8:11], v[144:147], v[24:27], v[8:11]
  v_mfma_f32_16x16x32_bf16 v[12:15], v[152:155], v[24:27], v[12:15]
  s_waitcnt vmcnt(7)
  buffer_load_dwordx4 v[72:75], v1, s[8:11], s62 offen offset:2048 nt
  v_mfma_f32_16x16x32_bf16 v[8:11], v[148:151], v[28:31], v[8:11]
  v_mfma_f32_16x16x32_bf16 v[12:15], v[156:159], v[28:31], v[12:15]
  v_mfma_f32_16x16x32_bf16 v[32:35], v[160:163], v[16:19], 0
  v_mfma_f32_16x16x32_bf16 v[36:39], v[168:171], v[16:19], 0
  s_waitcnt vmcnt(7)
  buffer_load_dwordx4 v[76:79], v2, s[8:11], s62 offen offset:2048 nt
  v_mfma_f32_16x16x32_bf16 v[32:35], v[164:167], v[20:23], v[32:35]
  v_mfma_f32_16x16x32_bf16 v[36:39], v[172:175], v[20:23], v[36:39]
  v_mfma_f32_16x16x32_bf16 v[32:35], v[176:179], v[24:27], v[32:35]
  s_waitcnt vmcnt(7)
  buffer_load_dwordx4 v[80:83], v1, s[8:11], s63 offen offset:0 nt
  v_mfma_f32_16x16x32_bf16 v[36:39], v[184:187], v[24:27], v[36:39]
  v_mfma_f32_16x16x32_bf16 v[32:35], v[180:183], v[28:31], v[32:35]
  v_mfma_f32_16x16x32_bf16 v[36:39], v[188:191], v[28:31], v[36:39]
  v_add_f32_dpp v8, v9, v8 row_ror:8 row_mask:0xf bank_mask:0xf
  s_waitcnt vmcnt(7)
  buffer_load_dwordx4 v[84:87], v2, s[8:11], s63 offen offset:0 nt
  v_add_f32_dpp v10, v11, v10 row_ror:8 row_mask:0xf bank_mask:0xf
  v_add_f32_dpp v12, v13, v12 row_ror:8 row_mask:0xf bank_mask:0xf
  v_add_f32_dpp v14, v15, v14 row_ror:8 row_mask:0xf bank_mask:0xf
  s_waitcnt vmcnt(7)
  buffer_load_dwordx4 v[88:91], v1, s[8:11], s63 offen offset:2048 nt
  v_cvt_pk_bf16_f32 v40, v8, v10
  v_cvt_pk_bf16_f32 v41, v12, v14
  v_lshlrev_b32 v8, 16, v40
  v_and_b32 v10, 0xffff0000, v40
  s_waitcnt vmcnt(7)
  buffer_load_dwordx4 v[92:95], v2, s[8:11], s63 offen offset:2048 nt
  s_mov_b64 exec, 1
  v_mov_b32 v49, 1
  ds_add_u32 v0, v49 offset:96
  s_mov_b64 exec, -1
  v_lshlrev_b32 v12, 16, v41
  v_and_b32 v14, 0xffff0000, v41
  v_mul_f32 v8, s52, v8
  s_waitcnt vmcnt(7)
  buffer_load_dwordx4 v[96:99], v1, s[8:11], s64 offen offset:0 nt
  v_mul_f32 v10, s52, v10
  v_mul_f32 v12, s52, v12
  v_mul_f32 v14, s52, v14
  s_waitcnt vmcnt(7)
  buffer_load_dwordx4 v[100:103], v2, s[8:11], s64 offen offset:0 nt
  v_cvt_pk_bf16_f32 v44, v8, v10
  v_cvt_pk_bf16_f32 v45, v12, v14
  v_max3_f32 v3, v3, v8, v10
  v_max3_f32 v3, v3, v12, v14
  s_waitcnt vmcnt(7)
  buffer_load_dwordx4 v[104:107], v1, s[8:11], s64 offen offset:2048 nt
  ds_write_b64 v4, v[44:45] offset:0
  v_add_f32_dpp v32, v33, v32 row_ror:8 row_mask:0xf bank_mask:0xf
  v_add_f32_dpp v34, v35, v34 row_ror:8 row_mask:0xf bank_mask:0xf
  s_waitcnt vmcnt(7)
  buffer_load_dwordx4 v[108:111], v2, s[8:11], s64 offen offset:2048 nt
  v_add_f32_dpp v36, v37, v36 row_ror:8 row_mask:0xf bank_mask:0xf
  v_add_f32_dpp v38, v39, v38 row_ror:8 row_mask:0xf bank_mask:0xf
  v_cvt_pk_bf16_f32 v42, v32, v34
  v_cvt_pk_bf16_f32 v43, v36, v38
  s_waitcnt vmcnt(7)
  buffer_load_dwordx4 v[112:115], v1, s[8:11], s65 offen offset:0 nt
  v_lshlrev_b32 v32, 16, v42
  v_and_b32 v34, 0xffff0000, v42
  v_lshlrev_b32 v36, 16, v43
  s_waitcnt vmcnt(7)
  buffer_load_dwordx4 v[116:119], v2, s[8:11], s65 offen offset:0 nt
  v_and_b32 v38, 0xffff0000, v43
  v_mul_f32 v32, s52, v32
  v_mul_f32 v34, s52, v34
  v_mul_f32 v36, s52, v36
  s_waitcnt vmcnt(7)
  buffer_load_dwordx4 v[120:123], v1, s[8:11], s65 offen offset:2048 nt
  v_mul_f32 v38, s52, v38
  v_cvt_pk_bf16_f32 v46, v32, v34
  v_cvt_pk_bf16_f32 v47, v36, v38
  s_waitcnt vmcnt(7)
  buffer_load_dwordx4 v[124:127], v2, s[8:11], s65 offen offset:2048 nt
  s_mov_b64 exec, 1
  v_mov_b32 v49, 1
  ds_add_u32 v0, v49 offset:96
  s_mov_b64 exec, -1
  ds_read_b32 v48, v0 offset:4
  v_max3_f32 v3, v3, v32, v34
  v_max3_f32 v3, v3, v36, v38
  ds_write_b64 v4, v[46:47] offset:512
  v_add_u32 v4, 1024, v4
  s_add_u32 s62, s62, 1048576
  s_add_u32 s63, s63, 1048576
  s_add_u32 s64, s64, 1048576
  s_add_u32 s65, s65, 1048576
  s_add_u32 s61, s61, 1
  s_waitcnt lgkmcnt(0)
  v_readfirstlane_b32 s66, v48
  s_cmp_eq_u32 s61, 8
  s_cbranch_scc1 L_trans
  s_lshl_b32 s67, s61, 5
  s_cmp_eq_u32 s66, 0
  s_cselect_b32 s66, s67, s66
  s_sub_i32 s66, s66, s67
  s_cmp_lt_i32 s66, -6
  s_cbranch_scc1 L_KS2
  s_cmp_lt_i32 s66, 8
  s_cbranch_scc1 L_KN2
L_KB2:
  s_waitcnt vmcnt(7)
  buffer_load_dwordx4 v[128:131], v1, s[8:11], s62 offen offset:0 nt
  v_mfma_f32_16x16x32_bf16 v[8:11], v[192:195], v[16:19], 0
  v_mfma_f32_16x16x32_bf16 v[12:15], v[200:203], v[16:19], 0
  v_mfma_f32_16x16x32_bf16 v[8:11], v[196:199], v[20:23], v[8:11]
  s_waitcnt vmcnt(7)
  buffer_load_dwordx4 v[132:135], v2, s[8:11], s62 offen offset:0 nt
  v_mfma_f32_16x16x32_bf16 v[12:15], v[204:207], v[20:23], v[12:15]
  v_mfma_f32_16x16x32_bf16 v[8:11], v[208:211], v[24:27], v[8:11]
  v_mfma_f32_16x16x32_bf16 v[12:15], v[216:219], v[24:27], v[12:15]
  s_waitcnt vmcnt(7)
  buffer_load_dwordx4 v[136:139], v1, s[8:11], s62 offen offset:2048 nt
  v_mfma_f32_16x16x32_bf16 v[8:11], v[212:215], v[28:31], v[8:11]
  v_mfma_f32_16x16x32_bf16 v[12:15], v[220:223], v[28:31], v[12:15]
  v_mfma_f32_16x16x32_bf16 v[32:35], v[224:227], v[16:19], 0
  v_mfma_f32_16x16x32_bf16 v[36:39], v[232:235], v[16:19], 0
  s_waitcnt vmcnt(7)
  buffer_load_dwordx4 v[140:143], v2, s[8:11], s62 offen offset:2048 nt
  v_mfma_f32_16x16x32_bf16 v[32:35], v[228:231], v[20:23], v[32:35]
  v_mfma_f32_16x16x32_bf16 v[36:39], v[236:239], v[20:23], v[36:39]
  v_mfma_f32_16x16x32_bf16 v[32:35], v[240:243], v[24:27], v[32:35]
  s_waitcnt vmcnt(7)
  buffer_load_dwordx4 v[144:147], v1, s[8:11], s63 offen offset:0 nt
  v_mfma_f32_16x16x32_bf16 v[36:39], v[248:251], v[24:27], v[36:39]
  v_mfma_f32_16x16x32_bf16 v[32:35], v[244:247], v[28:31], v[32:35]
  v_mfma_f32_16x16x32_bf16 v[36:39], v[252:255], v[28:31], v[36:39]
  v_add_f32_dpp v8, v9, v8 row_ror:8 row_mask:0xf bank_mask:0xf
  s_waitcnt vmcnt(7)
  buffer_load_dwordx4 v[148:151], v2, s[8:11], s63 offen offset:0 nt
  v_add_f32_dpp v10, v11, v10 row_ror:8 row_mask:0xf bank_mask:0xf
  v_add_f32_dpp v12, v13, v12 row_ror:8 row_mask:0xf bank_mask:0xf
  v_add_f32_dpp v14, v15, v14 row_ror:8 row_mask:0xf bank_mask:0xf
  s_waitcnt vmcnt(7)
  buffer_load_dwordx4 v[152:155], v1, s[8:11], s63 offen offset:2048 nt
  v_cvt_pk_bf16_f32 v40, v8, v10
  v_cvt_pk_bf16_f32 v41, v12, v14
  v_lshlrev_b32 v8, 16, v40
  v_and_b32 v10, 0xffff0000, v40
  s_waitcnt vmcnt(7)
  buffer_load_dwordx4 v[156:159], v2, s[8:11], s63 offen offset:2048 nt
  s_mov_b64 exec, 1
  v_mov_b32 v49, 1
  ds_add_u32 v0, v49 offset:96
  s_mov_b64 exec, -1
  v_lshlrev_b32 v12, 16, v41
  v_and_b32 v14, 0xffff0000, v41
  v_mul_f32 v8, s52, v8
  s_waitcnt vmcnt(7)
  buffer_load_dwordx4 v[160:163], v1, s[8:11], s64 offen offset:0 nt
  v_mul_f32 v10, s52, v10
  v_mul_f32 v12, s52, v12
  v_mul_f32 v14, s52, v14
  s_waitcnt vmcnt(7)
  buffer_load_dwordx4 v[164:167], v2, s[8:11], s64 offen offset:0 nt
  v_cvt_pk_bf16_f32 v44, v8, v10
  v_cvt_pk_bf16_f32 v45, v12, v14
  v_max3_f32 v3, v3, v8, v10
  v_max3_f32 v3, v3, v12, v14
  s_waitcnt vmcnt(7)
  buffer_load_dwordx4 v[168:171], v1, s[8:11], s64 offen offset:2048 nt
  ds_write_b64 v4, v[44:45] offset:0
  v_add_f32_dpp v32, v33, v32 row_ror:8 row_mask:0xf bank_mask:0xf
  v_add_f32_dpp v34, v35, v34 row_ror:8 row_mask:0xf bank_mask:0xf
  s_waitcnt vmcnt(7)
  buffer_load_dwordx4 v[172:175], v2, s[8:11], s64 offen offset:2048 nt
  v_add_f32_dpp v36, v37, v36 row_ror:8 row_mask:0xf bank_mask:0xf
  v_add_f32_dpp v38, v39, v38 row_ror:8 row_mask:0xf bank_mask:0xf
  v_cvt_pk_bf16_f32 v42, v32, v34
  v_cvt_pk_bf16_f32 v43, v36, v38
  s_waitcnt vmcnt(7)
  buffer_load_dwordx4 v[176:179], v1, s[8:11], s65 offen offset:0 nt
  v_lshlrev_b32 v32, 16, v42
  v_and_b32 v34, 0xffff0000, v42
  v_lshlrev_b32 v36, 16, v43
  s_waitcnt vmcnt(7)
  buffer_load_dwordx4 v[180:183], v2, s[8:11], s65 offen offset:0 nt
  v_and_b32 v38, 0xffff0000, v43
  v_mul_f32 v32, s52, v32
  v_mul_f32 v34, s52, v34
  v_mul_f32 v36, s52, v36
  s_waitcnt vmcnt(7)
  buffer_load_dwordx4 v[184:187], v1, s[8:11], s65 offen offset:2048 nt
  v_mul_f32 v38, s52, v38
  v_cvt_pk_bf16_f32 v46, v32, v34
  v_cvt_pk_bf16_f32 v47, v36, v38
  s_waitcnt vmcnt(7)
  buffer_load_dwordx4 v[188:191], v2, s[8:11], s65 offen offset:2048 nt
  s_mov_b64 exec, 1
  v_mov_b32 v49, 1
  ds_add_u32 v0, v49 offset:96
  s_mov_b64 exec, -1
  ds_read_b32 v48, v0 offset:4
  v_max3_f32 v3, v3, v32, v34
  v_max3_f32 v3, v3, v36, v38
  ds_write_b64 v4, v[46:47] offset:512
  v_add_u32 v4, 1024, v4
  s_add_u32 s62, s62, 1048576
  s_add_u32 s63, s63, 1048576
  s_add_u32 s64, s64, 1048576
  s_add_u32 s65, s65, 1048576
  s_add_u32 s61, s61, 1
  s_cmp_lg_u32 s61, 6
  s_cbranch_scc1 L_nswB
  s_add_u32 s62, s62, 4286578688
  s_add_u32 s63, s63, 4286578688
  s_add_u32 s64, s64, 4286578688
  s_add_u32 s65, s65, 4286578688
  s_mov_b32 s8, s20
  s_and_b32 s9, s21, 0xffff
  v_mov_b32 v1, v63
  v_add_u32 v2, 1024, v63
L_nswB:
  s_waitcnt lgkmcnt(0)
  v_readfirstlane_b32 s66, v48
  s_lshl_b32 s67, s61, 5
  s_cmp_eq_u32 s66, 0
  s_cselect_b32 s66, s67, s66
  s_sub_i32 s66, s66, s67
  s_cmp_lt_i32 s66, -6
  s_cbranch_scc1 L_KS0
  s_cmp_lt_i32 s66, 8
  s_cbranch_scc1 L_KN0
L_KB0:
  s_waitcnt vmcnt(7)
  buffer_load_dwordx4 v[192:195], v1, s[8:11], s62 offen offset:0 nt
  v_mfma_f32_16x16x32_bf16 v[8:11], v[64:67], v[16:19], 0
  v_mfma_f32_16x16x32_bf16 v[12:15], v[72:75], v[16:19], 0
  v_mfma_f32_16x16x32_bf16 v[8:11], v[68:71], v[20:23], v[8:11]
  s_waitcnt vmcnt(7)
  buffer_load_dwordx4 v[196:199], v2, s[8:11], s62 offen offset:0 nt
  v_mfma_f32_16x16x32_bf16 v[12:15], v[76:79], v[20:23], v[12:15]
  v_mfma_f32_16x16x32_bf16 v[8:11], v[80:83], v[24:27], v[8:11]
  v_mfma_f32_16x16x32_bf16 v[12:15], v[88:91], v[24:27], v[12:15]
  s_waitcnt vmcnt(7)
  buffer_load_dwordx4 v[200:203], v1, s[8:11], s62 offen offset:2048 nt
  v_mfma_f32_16x16x32_bf16 v[8:11], v[84:87], v[28:31], v[8:11]
  v_mfma_f32_16x16x32_bf16 v[12:15], v[92:95], v[28:31], v[12:15]
  v_mfma_f32_16x16x32_bf16 v[32:35], v[96:99], v[16:19], 0
  v_mfma_f32_16x16x32_bf16 v[36:39], v[104:107], v[16:19], 0
  s_waitcnt vmcnt(7)
  buffer_load_dwordx4 v[204:207], v2, s[8:11], s62 offen offset:2048 nt
  v_mfma_f32_16x16x32_bf16 v[32:35], v[100:103], v[20:23], v[32:35]
  v_mfma_f32_16x16x32_bf16 v[36:39], v[108:111], v[20:23], v[36:39]
  v_mfma_f32_16x16x32_bf16 v[32:35], v[112:115], v[24:27], v[32:35]
  s_waitcnt vmcnt(7)
  buffer_load_dwordx4 v[208:211], v1, s[8:11], s63 offen offset:0 nt
  v_mfma_f32_16x16x32_bf16 v[36:39], v[120:123], v[24:27], v[36:39]
  v_mfma_f32_16x16x32_bf16 v[32:35], v[116:119], v[28:31], v[32:35]
  v_mfma_f32_16x16x32_bf16 v[36:39], v[124:127], v[28:31], v[36:39]
  v_add_f32_dpp v8, v9, v8 row_ror:8 row_mask:0xf bank_mask:0xf
  s_waitcnt vmcnt(7)
  buffer_load_dwordx4 v[212:215], v2, s[8:11], s63 offen offset:0 nt
  v_add_f32_dpp v10, v11, v10 row_ror:8 row_mask:0xf bank_mask:0xf
  v_add_f32_dpp v12, v13, v12 row_ror:8 row_mask:0xf bank_mask:0xf
  v_add_f32_dpp v14, v15, v14 row_ror:8 row_mask:0xf bank_mask:0xf
  s_waitcnt vmcnt(7)
  buffer_load_dwordx4 v[216:219], v1, s[8:11], s63 offen offset:2048 nt
  v_cvt_pk_bf16_f32 v40, v8, v10
  v_cvt_pk_bf16_f32 v41, v12, v14
  v_lshlrev_b32 v8, 16, v40
  v_and_b32 v10, 0xffff0000, v40
  s_waitcnt vmcnt(7)
  buffer_load_dwordx4 v[220:223], v2, s[8:11], s63 offen offset:2048 nt
  s_mov_b64 exec, 1
  v_mov_b32 v49, 1
  ds_add_u32 v0, v49 offset:96
  s_mov_b64 exec, -1
  v_lshlrev_b32 v12, 16, v41
  v_and_b32 v14, 0xffff0000, v41
  v_mul_f32 v8, s52, v8
  s_waitcnt vmcnt(7)
  buffer_load_dwordx4 v[224:227], v1, s[8:11], s64 offen offset:0 nt
  v_mul_f32 v10, s52, v10
  v_mul_f32 v12, s52, v12
  v_mul_f32 v14, s52, v14
  s_waitcnt vmcnt(7)
  buffer_load_dwordx4 v[228:231], v2, s[8:11], s64 offen offset:0 nt
  v_cvt_pk_bf16_f32 v44, v8, v10
  v_cvt_pk_bf16_f32 v45, v12, v14
  v_max3_f32 v3, v3, v8, v10
  v_max3_f32 v3, v3, v12, v14
  s_waitcnt vmcnt(7)
  buffer_load_dwordx4 v[232:235], v1, s[8:11], s64 offen offset:2048 nt
  ds_write_b64 v4, v[44:45] offset:0
  v_add_f32_dpp v32, v33, v32 row_ror:8 row_mask:0xf bank_mask:0xf
  v_add_f32_dpp v34, v35, v34 row_ror:8 row_mask:0xf bank_mask:0xf
  s_waitcnt vmcnt(7)
  buffer_load_dwordx4 v[236:239], v2, s[8:11], s64 offen offset:2048 nt
  v_add_f32_dpp v36, v37, v36 row_ror:8 row_mask:0xf bank_mask:0xf
  v_add_f32_dpp v38, v39, v38 row_ror:8 row_mask:0xf bank_mask:0xf
  v_cvt_pk_bf16_f32 v42, v32, v34
  v_cvt_pk_bf16_f32 v43, v36, v38
  s_waitcnt vmcnt(7)
  buffer_load_dwordx4 v[240:243], v1, s[8:11], s65 offen offset:0 nt
  v_lshlrev_b32 v32, 16, v42
  v_and_b32 v34, 0xffff0000, v42
  v_lshlrev_b32 v36, 16, v43
  s_waitcnt vmcnt(7)
  buffer_load_dwordx4 v[244:247], v2, s[8:11], s65 offen offset:0 nt
  v_and_b32 v38, 0xffff0000, v43
  v_mul_f32 v32, s52, v32
  v_mul_f32 v34, s52, v34
  v_mul_f32 v36, s52, v36
  s_waitcnt vmcnt(7)
  buffer_load_dwordx4 v[248:251], v1, s[8:11], s65 offen offset:2048 nt
  v_mul_f32 v38, s52, v38
  v_cvt_pk_bf16_f32 v46, v32, v34
  v_cvt_pk_bf16_f32 v47, v36, v38
  s_waitcnt vmcnt(7)
  buffer_load_dwordx4 v[252:255], v2, s[8:11], s65 offen offset:2048 nt
  s_mov_b64 exec, 1
  v_mov_b32 v49, 1
  ds_add_u32 v0, v49 offset:96
  s_mov_b64 exec, -1
  ds_read_b32 v48, v0 offset:4
  v_max3_f32 v3, v3, v32, v34
  v_max3_f32 v3, v3, v36, v38
  ds_write_b64 v4, v[46:47] offset:512
  v_add_u32 v4, 1024, v4
  s_add_u32 s62, s62, 1048576
  s_add_u32 s63, s63, 1048576
  s_add_u32 s64, s64, 1048576
  s_add_u32 s65, s65, 1048576
  s_add_u32 s61, s61, 1
  s_waitcnt lgkmcnt(0)
  v_readfirstlane_b32 s66, v48
  s_lshl_b32 s67, s61, 5
  s_cmp_eq_u32 s66, 0
  s_cselect_b32 s66, s67, s66
  s_sub_i32 s66, s66, s67
  s_cmp_lt_i32 s66, -6
  s_cbranch_scc1 L_KS1
  s_cmp_lt_i32 s66, 8
  s_cbranch_scc1 L_KN1
  s_branch L_KB1
L_KS1:
  s_waitcnt vmcnt(4)
  buffer_load_dwordx4 v[64:67], v1, s[8:11], s62 offen offset:0 nt
  v_mfma_f32_16x16x32_bf16 v[8:11], v[128:131], v[16:19], 0
  v_mfma_f32_16x16x32_bf16 v[12:15], v[136:139], v[16:19], 0
  v_mfma_f32_16x16x32_bf16 v[8:11], v[132:135], v[20:23], v[8:11]
  s_waitcnt vmcnt(4)
  buffer_load_dwordx4 v[68:71], v2, s[8:11], s62 offen offset:0 nt
  v_mfma_f32_16x16x32_bf16 v[12:15], v[140:143], v[20:23], v[12:15]
  v_mfma_f32_16x16x32_bf16 v[8:11], v[144:147], v[24:27], v[8:11]
  v_mfma_f32_16x16x32_bf16 v[12:15], v[152:155], v[24:27], v[12:15]
  s_waitcnt vmcnt(4)
  buffer_load_dwordx4 v[72:75], v1, s[8:11], s62 offen offset:2048 nt
  v_mfma_f32_16x16x32_bf16 v[8:11], v[148:151], v[28:31], v[8:11]
  v_mfma_f32_16x16x32_bf16 v[12:15], v[156:159], v[28:31], v[12:15]
  v_mfma_f32_16x16x32_bf16 v[32:35], v[160:163], v[16:19], 0
  v_mfma_f32_16x16x32_bf16 v[36:39], v[168:171], v[16:19], 0
  s_waitcnt vmcnt(4)
  buffer_load_dwordx4 v[76:79], v2, s[8:11], s62 offen offset:2048 nt
  v_mfma_f32_16x16x32_bf16 v[32:35], v[164:167], v[20:23], v[32:35]
  v_mfma_f32_16x16x32_bf16 v[36:39], v[172:175], v[20:23], v[36:39]
  v_mfma_f32_16x16x32_bf16 v[32:35], v[176:179], v[24:27], v[32:35]
  s_waitcnt vmcnt(4)
  buffer_load_dwordx4 v[80:83], v1, s[8:11], s63 offen offset:0 nt
  v_mfma_f32_16x16x32_bf16 v[36:39], v[184:187], v[24:27], v[36:39]
  v_mfma_f32_16x16x32_bf16 v[32:35], v[180:183], v[28:31], v[32:35]
  v_mfma_f32_16x16x32_bf16 v[36:39], v[188:191], v[28:31], v[36:39]
  v_add_f32_dpp v8, v9, v8 row_ror:8 row_mask:0xf bank_mask:0xf
  s_waitcnt vmcnt(4)
  buffer_load_dwordx4 v[84:87], v2, s[8:11], s63 offen offset:0 nt
  v_add_f32_dpp v10, v11, v10 row_ror:8 row_mask:0xf bank_mask:0xf
  v_add_f32_dpp v12, v13, v12 row_ror:8 row_mask:0xf bank_mask:0xf
  v_add_f32_dpp v14, v15, v14 row_ror:8 row_mask:0xf bank_mask:0xf
  s_waitcnt vmcnt(4)
  buffer_load_dwordx4 v[88:91], v1, s[8:11], s63 offen offset:2048 nt
  v_cvt_pk_bf16_f32 v40, v8, v10
  v_cvt_pk_bf16_f32 v41, v12, v14
  v_lshlrev_b32 v8, 16, v40
  v_and_b32 v10, 0xffff0000, v40
  s_waitcnt vmcnt(4)
  buffer_load_dwordx4 v[92:95], v2, s[8:11], s63 offen offset:2048 nt
  s_mov_b64 exec, 1
  v_mov_b32 v49, 1
  ds_add_u32 v0, v49 offset:96
  s_mov_b64 exec, -1
  v_lshlrev_b32 v12, 16, v41
  v_and_b32 v14, 0xffff0000, v41
  v_mul_f32 v8, s52, v8
  s_waitcnt vmcnt(4)
  buffer_load_dwordx4 v[96:99], v1, s[8:11], s64 offen offset:0 nt
  v_mul_f32 v10, s52, v10
  v_mul_f32 v12, s52, v12
  v_mul_f32 v14, s52, v14
  s_waitcnt vmcnt(4)
  buffer_load_dwordx4 v[100:103], v2, s[8:11], s64 offen offset:0 nt
  v_cvt_pk_bf16_f32 v44, v8, v10
  v_cvt_pk_bf16_f32 v45, v12, v14
  v_max3_f32 v3, v3, v8, v10
  v_max3_f32 v3, v3, v12, v14
  s_waitcnt vmcnt(4)
  buffer_load_dwordx4 v[104:107], v1, s[8:11], s64 offen offset:2048 nt
  ds_write_b64 v4, v[44:45] offset:0
  v_add_f32_dpp v32, v33, v32 row_ror:8 row_mask:0xf bank_mask:0xf
  v_add_f32_dpp v34, v35, v34 row_ror:8 row_mask:0xf bank_mask:0xf
  s_waitcnt vmcnt(4)
  buffer_load_dwordx4 v[108:111], v2, s[8:11], s64 offen offset:2048 nt
  v_add_f32_dpp v36, v37, v36 row_ror:8 row_mask:0xf bank_mask:0xf
  v_add_f32_dpp v38, v39, v38 row_ror:8 row_mask:0xf bank_mask:0xf
  v_cvt_pk_bf16_f32 v42, v32, v34
  v_cvt_pk_bf16_f32 v43, v36, v38
  s_waitcnt vmcnt(4)
  buffer_load_dwordx4 v[112:115], v1, s[8:11], s65 offen offset:0 nt
  v_lshlrev_b32 v32, 16, v42
  v_and_b32 v34, 0xffff0000, v42
  v_lshlrev_b32 v36, 16, v43
  s_waitcnt vmcnt(4)
  buffer_load_dwordx4 v[116:119], v2, s[8:11], s65 offen offset:0 nt
  v_and_b32 v38, 0xffff0000, v43
  v_mul_f32 v32, s52, v32
  v_mul_f32 v34, s52, v34
  v_mul_f32 v36, s52, v36
  s_waitcnt vmcnt(4)
  buffer_load_dwordx4 v[120:123], v1, s[8:11], s65 offen offset:2048 nt
  v_mul_f32 v38, s52, v38
  v_cvt_pk_bf16_f32 v46, v32, v34
  v_cvt_pk_bf16_f32 v47, v36, v38
  s_waitcnt vmcnt(4)
  buffer_load_dwordx4 v[124:127], v2, s[8:11], s65 offen offset:2048 nt
  s_mov_b64 exec, 1
  v_mov_b32 v49, 1
  ds_add_u32 v0, v49 offset:96
  s_mov_b64 exec, -1
  ds_read_b32 v48, v0 offset:4
  v_max3_f32 v3, v3, v32, v34
  v_max3_f32 v3, v3, v36, v38
  ds_write_b64 v4, v[46:47] offset:512
  v_add_u32 v4, 1024, v4
  s_add_u32 s62, s62, 1048576
  s_add_u32 s63, s63, 1048576
  s_add_u32 s64, s64, 1048576
  s_add_u32 s65, s65, 1048576
  s_add_u32 s61, s61, 1
  s_waitcnt lgkmcnt(0)
  v_readfirstlane_b32 s66, v48
  s_cmp_eq_u32 s61, 8
  s_cbranch_scc1 L_trans
  s_lshl_b32 s67, s61, 5
  s_cmp_eq_u32 s66, 0
  s_cselect_b32 s66, s67, s66
  s_sub_i32 s66, s66, s67
  s_cmp_ge_i32 s66, 8
  s_cbranch_scc1 L_KB2
  s_cmp_ge_i32 s66, -6
  s_cbranch_scc1 L_KN2
L_KS2:
  s_waitcnt vmcnt(4)
  buffer_load_dwordx4 v[128:131], v1, s[8:11], s62 offen offset:0 nt
  v_mfma_f32_16x16x32_bf16 v[8:11], v[192:195], v[16:19], 0
  v_mfma_f32_16x16x32_bf16 v[12:15], v[200:203], v[16:19], 0
  v_mfma_f32_16x16x32_bf16 v[8:11], v[196:199], v[20:23], v[8:11]
  s_waitcnt vmcnt(4)
  buffer_load_dwordx4 v[132:135], v2, s[8:11], s62 offen offset:0 nt
  v_mfma_f32_16x16x32_bf16 v[12:15], v[204:207], v[20:23], v[12:15]
  v_mfma_f32_16x16x32_bf16 v[8:11], v[208:211], v[24:27], v[8:11]
  v_mfma_f32_16x16x32_bf16 v[12:15], v[216:219], v[24:27], v[12:15]
  s_waitcnt vmcnt(4)
  buffer_load_dwordx4 v[136:139], v1, s[8:11], s62 offen offset:2048 nt
  v_mfma_f32_16x16x32_bf16 v[8:11], v[212:215], v[28:31], v[8:11]
  v_mfma_f32_16x16x32_bf16 v[12:15], v[220:223], v[28:31], v[12:15]
  v_mfma_f32_16x16x32_bf16 v[32:35], v[224:227], v[16:19], 0
  v_mfma_f32_16x16x32_bf16 v[36:39], v[232:235], v[16:19], 0
  s_waitcnt vmcnt(4)
  buffer_load_dwordx4 v[140:143], v2, s[8:11], s62 offen offset:2048 nt
  v_mfma_f32_16x16x32_bf16 v[32:35], v[228:231], v[20:23], v[32:35]
  v_mfma_f32_16x16x32_bf16 v[36:39], v[236:239], v[20:23], v[36:39]
  v_mfma_f32_16x16x32_bf16 v[32:35], v[240:243], v[24:27], v[32:35]
  s_waitcnt vmcnt(4)
  buffer_load_dwordx4 v[144:147], v1, s[8:11], s63 offen offset:0 nt
  v_mfma_f32_16x16x32_bf16 v[36:39], v[248:251], v[24:27], v[36:39]
  v_mfma_f32_16x16x32_bf16 v[32:35], v[244:247], v[28:31], v[32:35]
  v_mfma_f32_16x16x32_bf16 v[36:39], v[252:255], v[28:31], v[36:39]
  v_add_f32_dpp v8, v9, v8 row_ror:8 row_mask:0xf bank_mask:0xf
  s_waitcnt vmcnt(4)
  buffer_load_dwordx4 v[148:151], v2, s[8:11], s63 offen offset:0 nt
  v_add_f32_dpp v10, v11, v10 row_ror:8 row_mask:0xf bank_mask:0xf
  v_add_f32_dpp v12, v13, v12 row_ror:8 row_mask:0xf bank_mask:0xf
  v_add_f32_dpp v14, v15, v14 row_ror:8 row_mask:0xf bank_mask:0xf
  s_waitcnt vmcnt(4)
  buffer_load_dwordx4 v[152:155], v1, s[8:11], s63 offen offset:2048 nt
  v_cvt_pk_bf16_f32 v40, v8, v10
  v_cvt_pk_bf16_f32 v41, v12, v14
  v_lshlrev_b32 v8, 16, v40
  v_and_b32 v10, 0xffff0000, v40
  s_waitcnt vmcnt(4)
  buffer_load_dwordx4 v[156:159], v2, s[8:11], s63 offen offset:2048 nt
  s_mov_b64 exec, 1
  v_mov_b32 v49, 1
  ds_add_u32 v0, v49 offset:96
  s_mov_b64 exec, -1
  v_lshlrev_b32 v12, 16, v41
  v_and_b32 v14, 0xffff0000, v41
  v_mul_f32 v8, s52, v8
  s_waitcnt vmcnt(4)
  buffer_load_dwordx4 v[160:163], v1, s[8:11], s64 offen offset:0 nt
  v_mul_f32 v10, s52, v10
  v_mul_f32 v12, s52, v12
  v_mul_f32 v14, s52, v14
  s_waitcnt vmcnt(4)
  buffer_load_dwordx4 v[164:167], v2, s[8:11], s64 offen offset:0 nt
  v_cvt_pk_bf16_f32 v44, v8, v10
  v_cvt_pk_bf16_f32 v45, v12, v14
  v_max3_f32 v3, v3, v8, v10
  v_max3_f32 v3, v3, v12, v14
  s_waitcnt vmcnt(4)
  buffer_load_dwordx4 v[168:171], v1, s[8:11], s64 offen offset:2048 nt
  ds_write_b64 v4, v[44:45] offset:0
  v_add_f32_dpp v32, v33, v32 row_ror:8 row_mask:0xf bank_mask:0xf
  v_add_f32_dpp v34, v35, v34 row_ror:8 row_mask:0xf bank_mask:0xf
  s_waitcnt vmcnt(4)
  buffer_load_dwordx4 v[172:175], v2, s[8:11], s64 offen offset:2048 nt
  v_add_f32_dpp v36, v37, v36 row_ror:8 row_mask:0xf bank_mask:0xf
  v_add_f32_dpp v38, v39, v38 row_ror:8 row_mask:0xf bank_mask:0xf
  v_cvt_pk_bf16_f32 v42, v32, v34
  v_cvt_pk_bf16_f32 v43, v36, v38
  s_waitcnt vmcnt(4)
  buffer_load_dwordx4 v[176:179], v1, s[8:11], s65 offen offset:0 nt
  v_lshlrev_b32 v32, 16, v42
  v_and_b32 v34, 0xffff0000, v42
  v_lshlrev_b32 v36, 16, v43
  s_waitcnt vmcnt(4)
  buffer_load_dwordx4 v[180:183], v2, s[8:11], s65 offen offset:0 nt
  v_and_b32 v38, 0xffff0000, v43
  v_mul_f32 v32, s52, v32
  v_mul_f32 v34, s52, v34
  v_mul_f32 v36, s52, v36
  s_waitcnt vmcnt(4)
  buffer_load_dwordx4 v[184:187], v1, s[8:11], s65 offen offset:2048 nt
  v_mul_f32 v38, s52, v38
  v_cvt_pk_bf16_f32 v46, v32, v34
  v_cvt_pk_bf16_f32 v47, v36, v38
  s_waitcnt vmcnt(4)
  buffer_load_dwordx4 v[188:191], v2, s[8:11], s65 offen offset:2048 nt
  s_mov_b64 exec, 1
  v_mov_b32 v49, 1
  ds_add_u32 v0, v49 offset:96
  s_mov_b64 exec, -1
  ds_read_b32 v48, v0 offset:4
  v_max3_f32 v3, v3, v32, v34
  v_max3_f32 v3, v3, v36, v38
  ds_write_b64 v4, v[46:47] offset:512
  v_add_u32 v4, 1024, v4
  s_add_u32 s62, s62, 1048576
  s_add_u32 s63, s63, 1048576
  s_add_u32 s64, s64, 1048576
  s_add_u32 s65, s65, 1048576
  s_add_u32 s61, s61, 1
  s_cmp_lg_u32 s61, 6
  s_cbranch_scc1 L_nswS
  s_add_u32 s62, s62, 4286578688
  s_add_u32 s63, s63, 4286578688
  s_add_u32 s64, s64, 4286578688
  s_add_u32 s65, s65, 4286578688
  s_mov_b32 s8, s20
  s_and_b32 s9, s21, 0xffff
  v_mov_b32 v1, v63
  v_add_u32 v2, 1024, v63
L_nswS:
  s_waitcnt lgkmcnt(0)
  v_readfirstlane_b32 s66, v48
  s_lshl_b32 s67, s61, 5
  s_cmp_eq_u32 s66, 0
  s_cselect_b32 s66, s67, s66
  s_sub_i32 s66, s66, s67
  s_cmp_ge_i32 s66, 8
  s_cbranch_scc1 L_KB0
  s_cmp_ge_i32 s66, -6
  s_cbranch_scc1 L_KN0
L_KS0:
  s_waitcnt vmcnt(4)
  buffer_load_dwordx4 v[192:195], v1, s[8:11], s62 offen offset:0 nt
  v_mfma_f32_16x16x32_bf16 v[8:11], v[64:67], v[16:19], 0
  v_mfma_f32_16x16x32_bf16 v[12:15], v[72:75], v[16:19], 0
  v_mfma_f32_16x16x32_bf16 v[8:11], v[68:71], v[20:23], v[8:11]
  s_waitcnt vmcnt(4)
  buffer_load_dwordx4 v[196:199], v2, s[8:11], s62 offen offset:0 nt
  v_mfma_f32_16x16x32_bf16 v[12:15], v[76:79], v[20:23], v[12:15]
  v_mfma_f32_16x16x32_bf16 v[8:11], v[80:83], v[24:27], v[8:11]
  v_mfma_f32_16x16x32_bf16 v[12:15], v[88:91], v[24:27], v[12:15]
  s_waitcnt vmcnt(4)
  buffer_load_dwordx4 v[200:203], v1, s[8:11], s62 offen offset:2048 nt
  v_mfma_f32_16x16x32_bf16 v[8:11], v[84:87], v[28:31], v[8:11]
  v_mfma_f32_16x16x32_bf16 v[12:15], v[92:95], v[28:31], v[12:15]
  v_mfma_f32_16x16x32_bf16 v[32:35], v[96:99], v[16:19], 0
  v_mfma_f32_16x16x32_bf16 v[36:39], v[104:107], v[16:19], 0
  s_waitcnt vmcnt(4)
  buffer_load_dwordx4 v[204:207], v2, s[8:11], s62 offen offset:2048 nt
  v_mfma_f32_16x16x32_bf16 v[32:35], v[100:103], v[20:23], v[32:35]
  v_mfma_f32_16x16x32_bf16 v[36:39], v[108:111], v[20:23], v[36:39]
  v_mfma_f32_16x16x32_bf16 v[32:35], v[112:115], v[24:27], v[32:35]
  s_waitcnt vmcnt(4)
  buffer_load_dwordx4 v[208:211], v1, s[8:11], s63 offen offset:0 nt
  v_mfma_f32_16x16x32_bf16 v[36:39], v[120:123], v[24:27], v[36:39]
  v_mfma_f32_16x16x32_bf16 v[32:35], v[116:119], v[28:31], v[32:35]
  v_mfma_f32_16x16x32_bf16 v[36:39], v[124:127], v[28:31], v[36:39]
  v_add_f32_dpp v8, v9, v8 row_ror:8 row_mask:0xf bank_mask:0xf
  s_waitcnt vmcnt(4)
  buffer_load_dwordx4 v[212:215], v2, s[8:11], s63 offen offset:0 nt
  v_add_f32_dpp v10, v11, v10 row_ror:8 row_mask:0xf bank_mask:0xf
  v_add_f32_dpp v12, v13, v12 row_ror:8 row_mask:0xf bank_mask:0xf
  v_add_f32_dpp v14, v15, v14 row_ror:8 row_mask:0xf bank_mask:0xf
  s_waitcnt vmcnt(4)
  buffer_load_dwordx4 v[216:219], v1, s[8:11], s63 offen offset:2048 nt
  v_cvt_pk_bf16_f32 v40, v8, v10
  v_cvt_pk_bf16_f32 v41, v12, v14
  v_lshlrev_b32 v8, 16, v40
  v_and_b32 v10, 0xffff0000, v40
  s_waitcnt vmcnt(4)
  buffer_load_dwordx4 v[220:223], v2, s[8:11], s63 offen offset:2048 nt
  s_mov_b64 exec, 1
  v_mov_b32 v49, 1
  ds_add_u32 v0, v49 offset:96
  s_mov_b64 exec, -1
  v_lshlrev_b32 v12, 16, v41
  v_and_b32 v14, 0xffff0000, v41
  v_mul_f32 v8, s52, v8
  s_waitcnt vmcnt(4)
  buffer_load_dwordx4 v[224:227], v1, s[8:11], s64 offen offset:0 nt
  v_mul_f32 v10, s52, v10
  v_mul_f32 v12, s52, v12
  v_mul_f32 v14, s52, v14
  s_waitcnt vmcnt(4)
  buffer_load_dwordx4 v[228:231], v2, s[8:11], s64 offen offset:0 nt
  v_cvt_pk_bf16_f32 v44, v8, v10
  v_cvt_pk_bf16_f32 v45, v12, v14
  v_max3_f32 v3, v3, v8, v10
  v_max3_f32 v3, v3, v12, v14
  s_waitcnt vmcnt(4)
  buffer_load_dwordx4 v[232:235], v1, s[8:11], s64 offen offset:2048 nt
  ds_write_b64 v4, v[44:45] offset:0
  v_add_f32_dpp v32, v33, v32 row_ror:8 row_mask:0xf bank_mask:0xf
  v_add_f32_dpp v34, v35, v34 row_ror:8 row_mask:0xf bank_mask:0xf
  s_waitcnt vmcnt(4)
  buffer_load_dwordx4 v[236:239], v2, s[8:11], s64 offen offset:2048 nt
  v_add_f32_dpp v36, v37, v36 row_ror:8 row_mask:0xf bank_mask:0xf
  v_add_f32_dpp v38, v39, v38 row_ror:8 row_mask:0xf bank_mask:0xf
  v_cvt_pk_bf16_f32 v42, v32, v34
  v_cvt_pk_bf16_f32 v43, v36, v38
  s_waitcnt vmcnt(4)
  buffer_load_dwordx4 v[240:243], v1, s[8:11], s65 offen offset:0 nt
  v_lshlrev_b32 v32, 16, v42
  v_and_b32 v34, 0xffff0000, v42
  v_lshlrev_b32 v36, 16, v43
  s_waitcnt vmcnt(4)
  buffer_load_dwordx4 v[244:247], v2, s[8:11], s65 offen offset:0 nt
  v_and_b32 v38, 0xffff0000, v43
  v_mul_f32 v32, s52, v32
  v_mul_f32 v34, s52, v34
  v_mul_f32 v36, s52, v36
  s_waitcnt vmcnt(4)
  buffer_load_dwordx4 v[248:251], v1, s[8:11], s65 offen offset:2048 nt
  v_mul_f32 v38, s52, v38
  v_cvt_pk_bf16_f32 v46, v32, v34
  v_cvt_pk_bf16_f32 v47, v36, v38
  s_waitcnt vmcnt(4)
  buffer_load_dwordx4 v[252:255], v2, s[8:11], s65 offen offset:2048 nt
  s_mov_b64 exec, 1
  v_mov_b32 v49, 1
  ds_add_u32 v0, v49 offset:96
  s_mov_b64 exec, -1
  ds_read_b32 v48, v0 offset:4
  v_max3_f32 v3, v3, v32, v34
  v_max3_f32 v3, v3, v36, v38
  ds_write_b64 v4, v[46:47] offset:512
  v_add_u32 v4, 1024, v4
  s_add_u32 s62, s62, 1048576
  s_add_u32 s63, s63, 1048576
  s_add_u32 s64, s64, 1048576
  s_add_u32 s65, s65, 1048576
  s_add_u32 s61, s61, 1
  s_waitcnt lgkmcnt(0)
  v_readfirstlane_b32 s66, v48
  s_lshl_b32 s67, s61, 5
  s_cmp_eq_u32 s66, 0
  s_cselect_b32 s66, s67, s66
  s_sub_i32 s66, s66, s67
  s_cmp_ge_i32 s66, 8
  s_cbranch_scc1 L_KB1
  s_cmp_ge_i32 s66, -6
  s_cbranch_scc1 L_KN1
  s_branch L_KS1
L_trans:
  v_cvt_pk_bf16_f32 v3, v3, v3
  v_and_b32 v3, 0xffff0000, v3
  s_nop 1
  v_max_f32_dpp v3, v3, v3 row_half_mirror row_mask:0xf bank_mask:0xf
  v_mov_b32 v7, v3
  s_nop 1
  v_permlane16_swap_b32 v3, v7
  v_max_f32 v3, v3, v7
  v_mov_b32 v7, v3
  s_nop 1
  v_permlane32_swap_b32 v3, v7
  v_max_f32 v3, v3, v7
  v_mul_f32 v3, s53, v3
  v_subrev_u32 v4, 8192, v4
  v_mov_b32 v16, 0
  v_pk_mul_f32 v[32:33], 0, 0
  v_pk_mul_f32 v[34:35], 0, 0
  v_pk_mul_f32 v[36:37], 0, 0
  v_pk_mul_f32 v[38:39], 0, 0
  v_pk_mul_f32 v[40:41], 0, 0
  v_pk_mul_f32 v[42:43], 0, 0
  v_pk_mul_f32 v[44:45], 0, 0
  v_pk_mul_f32 v[46:47], 0, 0
  v_pk_mul_f32 v[48:49], 0, 0
  v_pk_mul_f32 v[50:51], 0, 0
  v_pk_mul_f32 v[52:53], 0, 0
  v_pk_mul_f32 v[54:55], 0, 0
  v_pk_mul_f32 v[56:57], 0, 0
  v_pk_mul_f32 v[58:59], 0, 0
  v_pk_mul_f32 v[60:61], 0, 0
  v_pk_mul_f32 v[62:63], 0, 0
  s_lshl_b32 s67, s61, 5
  s_cmp_eq_u32 s66, 0
  s_cselect_b32 s66, s67, s66
  s_sub_i32 s66, s66, s67
  s_cmp_ge_u32 s61, 13
  s_cselect_b32 s67, 64, 0
  s_add_i32 s66, s66, s67
  s_cmp_ge_i32 s66, 8
  s_cbranch_scc1 L_VB2
  s_cmp_lt_i32 s66, -6
  s_cbranch_scc1 L_VS2
L_VN2:
  s_waitcnt vmcnt(5)
  buffer_load_dwordx4 v[128:131], v1, s[8:11], s62 offen offset:0 nt
  ds_read_b64 v[20:21], v4 offset:0
  ds_read_b64 v[22:23], v4 offset:512
  v_add_u32 v4, 1024, v4
  s_waitcnt lgkmcnt(0)
  v_lshlrev_b32 v24, 16, v20
  v_and_b32 v25, 0xffff0000, v20
  v_lshlrev_b32 v26, 16, v21
  s_waitcnt vmcnt(5)
  buffer_load_dwordx4 v[132:135], v2, s[8:11], s62 offen offset:0 nt
  v_and_b32 v27, 0xffff0000, v21
  v_lshlrev_b32 v28, 16, v22
  v_and_b32 v29, 0xffff0000, v22
  v_lshlrev_b32 v30, 16, v23
  v_and_b32 v31, 0xffff0000, v23
  v_fma_f32 v24, v24, s53, -v3
  v_fma_f32 v25, v25, s53, -v3
  v_fma_f32 v26, v26, s53, -v3
  s_waitcnt vmcnt(5)
  buffer_load_dwordx4 v[136:139], v1, s[8:11], s62 offen offset:2048 nt
  v_fma_f32 v27, v27, s53, -v3
  v_fma_f32 v28, v28, s53, -v3
  v_fma_f32 v29, v29, s53, -v3
  v_fma_f32 v30, v30, s53, -v3
  v_fma_f32 v31, v31, s53, -v3
  v_exp_f32 v24, v24
  v_exp_f32 v25, v25
  v_exp_f32 v26, v26
  s_waitcnt vmcnt(5)
  buffer_load_dwordx4 v[140:143], v2, s[8:11], s62 offen offset:2048 nt
  v_exp_f32 v27, v27
  v_exp_f32 v28, v28
  v_exp_f32 v29, v29
  v_exp_f32 v30, v30
  v_exp_f32 v31, v31
  v_cvt_pk_bf16_f32 v8, v24, v25
  v_cvt_pk_bf16_f32 v9, v26, v27
  v_cvt_pk_bf16_f32 v12, v28, v29
  s_waitcnt vmcnt(5)
  buffer_load_dwordx4 v[144:147], v1, s[8:11], s63 offen offset:0 nt
  v_cvt_pk_bf16_f32 v13, v30, v31
  v_add_f32 v24, v24, v25
  v_add_f32 v26, v26, v27
  v_add_f32 v28, v28, v29
  v_add_f32 v30, v30, v31
  v_mov_b32_dpp v10, v8 row_half_mirror row_mask:0xf bank_mask:0xf
  v_mov_b32_dpp v11, v9 row_half_mirror row_mask:0xf bank_mask:0xf
  s_waitcnt vmcnt(5)
  buffer_load_dwordx4 v[148:151], v2, s[8:11], s63 offen offset:0 nt
  v_mov_b32_dpp v14, v12 row_half_mirror row_mask:0xf bank_mask:0xf
  v_mov_b32_dpp v15, v13 row_half_mirror row_mask:0xf bank_mask:0xf
  v_add_f32 v24, v24, v26
  v_add_f32 v28, v28, v30
  v_add_f32 v16, v16, v24
  v_add_f32 v16, v16, v28
  v_perm_b32 v20, v196, v192, s50
  v_perm_b32 v21, v204, v200, s50
  s_waitcnt vmcnt(5)
  buffer_load_dwordx4 v[152:155], v1, s[8:11], s63 offen offset:2048 nt
  v_perm_b32 v22, v212, v208, s50
  v_perm_b32 v23, v220, v216, s50
  v_perm_b32 v24, v196, v192, s51
  v_perm_b32 v25, v204, v200, s51
  v_perm_b32 v26, v212, v208, s51
  v_perm_b32 v27, v220, v216, s51
  v_mfma_f32_16x16x32_bf16 v[32:35], v[20:23], v[8:11], v[32:35]
  v_perm_b32 v28, v197, v193, s50
  s_waitcnt vmcnt(5)
  buffer_load_dwordx4 v[156:159], v2, s[8:11], s63 offen offset:2048 nt
  s_mov_b64 exec, 1
  v_mov_b32 v19, 1
  ds_add_u32 v0, v19 offset:96
  s_mov_b64 exec, -1
  v_perm_b32 v29, v205, v201, s50
  v_perm_b32 v30, v213, v209, s50
  v_perm_b32 v31, v221, v217, s50
  v_mfma_f32_16x16x32_bf16 v[36:39], v[24:27], v[8:11], v[36:39]
  v_perm_b32 v20, v197, v193, s51
  v_perm_b32 v21, v205, v201, s51
  v_perm_b32 v22, v213, v209, s51
  v_perm_b32 v23, v221, v217, s51
  s_waitcnt vmcnt(5)
  buffer_load_dwordx4 v[160:163], v1, s[8:11], s64 offen offset:0 nt
  v_mfma_f32_16x16x32_bf16 v[40:43], v[28:31], v[8:11], v[40:43]
  v_perm_b32 v24, v198, v194, s50
  v_perm_b32 v25, v206, v202, s50
  v_perm_b32 v26, v214, v210, s50
  v_perm_b32 v27, v222, v218, s50
  v_mfma_f32_16x16x32_bf16 v[44:47], v[20:23], v[8:11], v[44:47]
  v_perm_b32 v28, v198, v194, s51
  s_waitcnt vmcnt(5)
  buffer_load_dwordx4 v[164:167], v2, s[8:11], s64 offen offset:0 nt
  v_perm_b32 v29, v206, v202, s51
  v_perm_b32 v30, v214, v210, s51
  v_perm_b32 v31, v222, v218, s51
  v_mfma_f32_16x16x32_bf16 v[48:51], v[24:27], v[8:11], v[48:51]
  v_perm_b32 v20, v199, v195, s50
  v_perm_b32 v21, v207, v203, s50
  v_perm_b32 v22, v215, v211, s50
  v_perm_b32 v23, v223, v219, s50
  s_waitcnt vmcnt(5)
  buffer_load_dwordx4 v[168:171], v1, s[8:11], s64 offen offset:2048 nt
  v_mfma_f32_16x16x32_bf16 v[52:55], v[28:31], v[8:11], v[52:55]
  v_perm_b32 v24, v199, v195, s51
  v_perm_b32 v25, v207, v203, s51
  v_perm_b32 v26, v215, v211, s51
  v_perm_b32 v27, v223, v219, s51
  v_mfma_f32_16x16x32_bf16 v[56:59], v[20:23], v[8:11], v[56:59]
  v_perm_b32 v28, v228, v224, s50
  v_perm_b32 v29, v236, v232, s50
  s_waitcnt vmcnt(5)
  buffer_load_dwordx4 v[172:175], v2, s[8:11], s64 offen offset:2048 nt
  v_perm_b32 v30, v244, v240, s50
  v_perm_b32 v31, v252, v248, s50
  v_mfma_f32_16x16x32_bf16 v[60:63], v[24:27], v[8:11], v[60:63]
  v_perm_b32 v20, v228, v224, s51
  v_perm_b32 v21, v236, v232, s51
  v_perm_b32 v22, v244, v240, s51
  v_perm_b32 v23, v252, v248, s51
  v_mfma_f32_16x16x32_bf16 v[32:35], v[28:31], v[12:15], v[32:35]
  s_waitcnt vmcnt(5)
  buffer_load_dwordx4 v[176:179], v1, s[8:11], s65 offen offset:0 nt
  v_perm_b32 v24, v229, v225, s50
  v_perm_b32 v25, v237, v233, s50
  v_perm_b32 v26, v245, v241, s50
  v_perm_b32 v27, v253, v249, s50
  v_mfma_f32_16x16x32_bf16 v[36:39], v[20:23], v[12:15], v[36:39]
  v_perm_b32 v28, v229, v225, s51
  v_perm_b32 v29, v237, v233, s51
  s_waitcnt vmcnt(5)
  buffer_load_dwordx4 v[180:183], v2, s[8:11], s65 offen offset:0 nt
  v_perm_b32 v30, v245, v241, s51
  v_perm_b32 v31, v253, v249, s51
  v_mfma_f32_16x16x32_bf16 v[40:43], v[24:27], v[12:15], v[40:43]
  v_perm_b32 v20, v230, v226, s50
  v_perm_b32 v21, v238, v234, s50
  v_perm_b32 v22, v246, v242, s50
  v_perm_b32 v23, v254, v250, s50
  v_mfma_f32_16x16x32_bf16 v[44:47], v[28:31], v[12:15], v[44:47]
  s_waitcnt vmcnt(5)
  buffer_load_dwordx4 v[184:187], v1, s[8:11], s65 offen offset:2048 nt
  v_perm_b32 v24, v230, v226, s51
  v_perm_b32 v25, v238, v234, s51
  v_perm_b32 v26, v246, v242, s51
  v_perm_b32 v27, v254, v250, s51
  v_mfma_f32_16x16x32_bf16 v[48:51], v[20:23], v[12:15], v[48:51]
  v_perm_b32 v28, v231, v227, s50
  v_perm_b32 v29, v239, v235, s50
  v_perm_b32 v30, v247, v243, s50
  s_waitcnt vmcnt(5)
  buffer_load_dwordx4 v[188:191], v2, s[8:11], s65 offen offset:2048 nt
  s_mov_b64 exec, 1
  v_mov_b32 v19, 1
  ds_add_u32 v0, v19 offset:96
  s_mov_b64 exec, -1
  ds_read_b32 v18, v0 offset:4
  v_perm_b32 v31, v255, v251, s50
  v_mfma_f32_16x16x32_bf16 v[52:55], v[24:27], v[12:15], v[52:55]
  v_perm_b32 v20, v231, v227, s51
  v_perm_b32 v21, v239, v235, s51
  v_perm_b32 v22, v247, v243, s51
  v_perm_b32 v23, v255, v251, s51
  v_mfma_f32_16x16x32_bf16 v[56:59], v[28:31], v[12:15], v[56:59]
  s_nop 0
  v_mfma_f32_16x16x32_bf16 v[60:63], v[20:23], v[12:15], v[60:63]
  s_add_u32 s62, s62, 1048576
  s_add_u32 s63, s63, 1048576
  s_add_u32 s64, s64, 1048576
  s_add_u32 s65, s65, 1048576
  s_add_u32 s61, s61, 1
  s_waitcnt lgkmcnt(0)
  v_readfirstlane_b32 s66, v18
  s_lshl_b32 s67, s61, 5
  s_cmp_eq_u32 s66, 0
  s_cselect_b32 s66, s67, s66
  s_sub_i32 s66, s66, s67
  s_cmp_ge_u32 s61, 13
  s_cselect_b32 s67, 64, 0
  s_add_i32 s66, s66, s67
  s_cmp_ge_i32 s66, 8
  s_cbranch_scc1 L_VB0
  s_cmp_lt_i32 s66, -6
  s_cbranch_scc1 L_VS0
L_VN0:
  s_waitcnt vmcnt(5)
  buffer_load_dwordx4 v[192:195], v1, s[8:11], s62 offen offset:0 nt
  ds_read_b64 v[20:21], v4 offset:0
  ds_read_b64 v[22:23], v4 offset:512
  v_add_u32 v4, 1024, v4
  s_waitcnt lgkmcnt(0)
  v_lshlrev_b32 v24, 16, v20
  v_and_b32 v25, 0xffff0000, v20
  v_lshlrev_b32 v26, 16, v21
  s_waitcnt vmcnt(5)
  buffer_load_dwordx4 v[196:199], v2, s[8:11], s62 offen offset:0 nt
  v_and_b32 v27, 0xffff0000, v21
  v_lshlrev_b32 v28, 16, v22
  v_and_b32 v29, 0xffff0000, v22
  v_lshlrev_b32 v30, 16, v23
  v_and_b32 v31, 0xffff0000, v23
  v_fma_f32 v24, v24, s53, -v3
  v_fma_f32 v25, v25, s53, -v3
  v_fma_f32 v26, v26, s53, -v3
  s_waitcnt vmcnt(5)
  buffer_load_dwordx4 v[200:203], v1, s[8:11], s62 offen offset:2048 nt
  v_fma_f32 v27, v27, s53, -v3
  v_fma_f32 v28, v28, s53, -v3
  v_fma_f32 v29, v29, s53, -v3
  v_fma_f32 v30, v30, s53, -v3
  v_fma_f32 v31, v31, s53, -v3
  v_exp_f32 v24, v24
  v_exp_f32 v25, v25
  v_exp_f32 v26, v26
  s_waitcnt vmcnt(5)
  buffer_load_dwordx4 v[204:207], v2, s[8:11], s62 offen offset:2048 nt
  v_exp_f32 v27, v27
  v_exp_f32 v28, v28
  v_exp_f32 v29, v29
  v_exp_f32 v30, v30
  v_exp_f32 v31, v31
  v_cvt_pk_bf16_f32 v8, v24, v25
  v_cvt_pk_bf16_f32 v9, v26, v27
  v_cvt_pk_bf16_f32 v12, v28, v29
  s_waitcnt vmcnt(5)
  buffer_load_dwordx4 v[208:211], v1, s[8:11], s63 offen offset:0 nt
  v_cvt_pk_bf16_f32 v13, v30, v31
  v_add_f32 v24, v24, v25
  v_add_f32 v26, v26, v27
  v_add_f32 v28, v28, v29
  v_add_f32 v30, v30, v31
  v_mov_b32_dpp v10, v8 row_half_mirror row_mask:0xf bank_mask:0xf
  v_mov_b32_dpp v11, v9 row_half_mirror row_mask:0xf bank_mask:0xf
  s_waitcnt vmcnt(5)
  buffer_load_dwordx4 v[212:215], v2, s[8:11], s63 offen offset:0 nt
  v_mov_b32_dpp v14, v12 row_half_mirror row_mask:0xf bank_mask:0xf
  v_mov_b32_dpp v15, v13 row_half_mirror row_mask:0xf bank_mask:0xf
  v_add_f32 v24, v24, v26
  v_add_f32 v28, v28, v30
  v_add_f32 v16, v16, v24
  v_add_f32 v16, v16, v28
  v_perm_b32 v20, v68, v64, s50
  v_perm_b32 v21, v76, v72, s50
  s_waitcnt vmcnt(5)
  buffer_load_dwordx4 v[216:219], v1, s[8:11], s63 offen offset:2048 nt
  v_perm_b32 v22, v84, v80, s50
  v_perm_b32 v23, v92, v88, s50
  v_perm_b32 v24, v68, v64, s51
  v_perm_b32 v25, v76, v72, s51
  v_perm_b32 v26, v84, v80, s51
  v_perm_b32 v27, v92, v88, s51
  v_mfma_f32_16x16x32_bf16 v[32:35], v[20:23], v[8:11], v[32:35]
  v_perm_b32 v28, v69, v65, s50
  s_waitcnt vmcnt(5)
  buffer_load_dwordx4 v[220:223], v2, s[8:11], s63 offen offset:2048 nt
  s_mov_b64 exec, 1
  v_mov_b32 v19, 1
  ds_add_u32 v0, v19 offset:96
  s_mov_b64 exec, -1
  v_perm_b32 v29, v77, v73, s50
  v_perm_b32 v30, v85, v81, s50
  v_perm_b32 v31, v93, v89, s50
  v_mfma_f32_16x16x32_bf16 v[36:39], v[24:27], v[8:11], v[36:39]
  v_perm_b32 v20, v69, v65, s51
  v_perm_b32 v21, v77, v73, s51
  v_perm_b32 v22, v85, v81, s51
  v_perm_b32 v23, v93, v89, s51
  s_waitcnt vmcnt(5)
  buffer_load_dwordx4 v[224:227], v1, s[8:11], s64 offen offset:0 nt
  v_mfma_f32_16x16x32_bf16 v[40:43], v[28:31], v[8:11], v[40:43]
  v_perm_b32 v24, v70, v66, s50
  v_perm_b32 v25, v78, v74, s50
  v_perm_b32 v26, v86, v82, s50
  v_perm_b32 v27, v94, v90, s50
  v_mfma_f32_16x16x32_bf16 v[44:47], v[20:23], v[8:11], v[44:47]
  v_perm_b32 v28, v70, v66, s51
  s_waitcnt vmcnt(5)
  buffer_load_dwordx4 v[228:231], v2, s[8:11], s64 offen offset:0 nt
  v_perm_b32 v29, v78, v74, s51
  v_perm_b32 v30, v86, v82, s51
  v_perm_b32 v31, v94, v90, s51
  v_mfma_f32_16x16x32_bf16 v[48:51], v[24:27], v[8:11], v[48:51]
  v_perm_b32 v20, v71, v67, s50
  v_perm_b32 v21, v79, v75, s50
  v_perm_b32 v22, v87, v83, s50
  v_perm_b32 v23, v95, v91, s50
  s_waitcnt vmcnt(5)
  buffer_load_dwordx4 v[232:235], v1, s[8:11], s64 offen offset:2048 nt
  v_mfma_f32_16x16x32_bf16 v[52:55], v[28:31], v[8:11], v[52:55]
  v_perm_b32 v24, v71, v67, s51
  v_perm_b32 v25, v79, v75, s51
  v_perm_b32 v26, v87, v83, s51
  v_perm_b32 v27, v95, v91, s51
  v_mfma_f32_16x16x32_bf16 v[56:59], v[20:23], v[8:11], v[56:59]
  v_perm_b32 v28, v100, v96, s50
  v_perm_b32 v29, v108, v104, s50
  s_waitcnt vmcnt(5)
  buffer_load_dwordx4 v[236:239], v2, s[8:11], s64 offen offset:2048 nt
  v_perm_b32 v30, v116, v112, s50
  v_perm_b32 v31, v124, v120, s50
  v_mfma_f32_16x16x32_bf16 v[60:63], v[24:27], v[8:11], v[60:63]
  v_perm_b32 v20, v100, v96, s51
  v_perm_b32 v21, v108, v104, s51
  v_perm_b32 v22, v116, v112, s51
  v_perm_b32 v23, v124, v120, s51
  v_mfma_f32_16x16x32_bf16 v[32:35], v[28:31], v[12:15], v[32:35]
  s_waitcnt vmcnt(5)
  buffer_load_dwordx4 v[240:243], v1, s[8:11], s65 offen offset:0 nt
  v_perm_b32 v24, v101, v97, s50
  v_perm_b32 v25, v109, v105, s50
  v_perm_b32 v26, v117, v113, s50
  v_perm_b32 v27, v125, v121, s50
  v_mfma_f32_16x16x32_bf16 v[36:39], v[20:23], v[12:15], v[36:39]
  v_perm_b32 v28, v101, v97, s51
  v_perm_b32 v29, v109, v105, s51
  s_waitcnt vmcnt(5)
  buffer_load_dwordx4 v[244:247], v2, s[8:11], s65 offen offset:0 nt
  v_perm_b32 v30, v117, v113, s51
  v_perm_b32 v31, v125, v121, s51
  v_mfma_f32_16x16x32_bf16 v[40:43], v[24:27], v[12:15], v[40:43]
  v_perm_b32 v20, v102, v98, s50
  v_perm_b32 v21, v110, v106, s50
  v_perm_b32 v22, v118, v114, s50
  v_perm_b32 v23, v126, v122, s50
  v_mfma_f32_16x16x32_bf16 v[44:47], v[28:31], v[12:15], v[44:47]
  s_waitcnt vmcnt(5)
  buffer_load_dwordx4 v[248:251], v1, s[8:11], s65 offen offset:2048 nt
  v_perm_b32 v24, v102, v98, s51
  v_perm_b32 v25, v110, v106, s51
  v_perm_b32 v26, v118, v114, s51
  v_perm_b32 v27, v126, v122, s51
  v_mfma_f32_16x16x32_bf16 v[48:51], v[20:23], v[12:15], v[48:51]
  v_perm_b32 v28, v103, v99, s50
  v_perm_b32 v29, v111, v107, s50
  v_perm_b32 v30, v119, v115, s50
  s_waitcnt vmcnt(5)
  buffer_load_dwordx4 v[252:255], v2, s[8:11], s65 offen offset:2048 nt
  s_mov_b64 exec, 1
  v_mov_b32 v19, 1
  ds_add_u32 v0, v19 offset:96
  s_mov_b64 exec, -1
  ds_read_b32 v18, v0 offset:4
  v_perm_b32 v31, v127, v123, s50
  v_mfma_f32_16x16x32_bf16 v[52:55], v[24:27], v[12:15], v[52:55]
  v_perm_b32 v20, v103, v99, s51
  v_perm_b32 v21, v111, v107, s51
  v_perm_b32 v22, v119, v115, s51
  v_perm_b32 v23, v127, v123, s51
  v_mfma_f32_16x16x32_bf16 v[56:59], v[28:31], v[12:15], v[56:59]
  s_nop 0
  v_mfma_f32_16x16x32_bf16 v[60:63], v[20:23], v[12:15], v[60:63]
  s_add_u32 s62, s62, 1048576
  s_add_u32 s63, s63, 1048576
  s_add_u32 s64, s64, 1048576
  s_add_u32 s65, s65, 1048576
  s_add_u32 s61, s61, 1
  s_waitcnt lgkmcnt(0)
  v_readfirstlane_b32 s66, v18
  s_lshl_b32 s67, s61, 5
  s_cmp_eq_u32 s66, 0
  s_cselect_b32 s66, s67, s66
  s_sub_i32 s66, s66, s67
  s_cmp_ge_u32 s61, 13
  s_cselect_b32 s67, 64, 0
  s_add_i32 s66, s66, s67
  s_cmp_ge_i32 s66, 8
  s_cbranch_scc1 L_VB1
  s_cmp_lt_i32 s66, -6
  s_cbranch_scc1 L_VS1
L_VN1:
  s_waitcnt vmcnt(5)
  buffer_load_dwordx4 v[64:67], v1, s[8:11], s62 offen offset:0 nt
  ds_read_b64 v[20:21], v4 offset:0
  ds_read_b64 v[22:23], v4 offset:512
  v_add_u32 v4, 1024, v4
  s_waitcnt lgkmcnt(0)
  v_lshlrev_b32 v24, 16, v20
  v_and_b32 v25, 0xffff0000, v20
  v_lshlrev_b32 v26, 16, v21
  s_waitcnt vmcnt(5)
  buffer_load_dwordx4 v[68:71], v2, s[8:11], s62 offen offset:0 nt
  v_and_b32 v27, 0xffff0000, v21
  v_lshlrev_b32 v28, 16, v22
  v_and_b32 v29, 0xffff0000, v22
  v_lshlrev_b32 v30, 16, v23
  v_and_b32 v31, 0xffff0000, v23
  v_fma_f32 v24, v24, s53, -v3
  v_fma_f32 v25, v25, s53, -v3
  v_fma_f32 v26, v26, s53, -v3
  s_waitcnt vmcnt(5)
  buffer_load_dwordx4 v[72:75], v1, s[8:11], s62 offen offset:2048 nt
  v_fma_f32 v27, v27, s53, -v3
  v_fma_f32 v28, v28, s53, -v3
  v_fma_f32 v29, v29, s53, -v3
  v_fma_f32 v30, v30, s53, -v3
  v_fma_f32 v31, v31, s53, -v3
  v_exp_f32 v24, v24
  v_exp_f32 v25, v25
  v_exp_f32 v26, v26
  s_waitcnt vmcnt(5)
  buffer_load_dwordx4 v[76:79], v2, s[8:11], s62 offen offset:2048 nt
  v_exp_f32 v27, v27
  v_exp_f32 v28, v28
  v_exp_f32 v29, v29
  v_exp_f32 v30, v30
  v_exp_f32 v31, v31
  v_cvt_pk_bf16_f32 v8, v24, v25
  v_cvt_pk_bf16_f32 v9, v26, v27
  v_cvt_pk_bf16_f32 v12, v28, v29
  s_waitcnt vmcnt(5)
  buffer_load_dwordx4 v[80:83], v1, s[8:11], s63 offen offset:0 nt
  v_cvt_pk_bf16_f32 v13, v30, v31
  v_add_f32 v24, v24, v25
  v_add_f32 v26, v26, v27
  v_add_f32 v28, v28, v29
  v_add_f32 v30, v30, v31
  v_mov_b32_dpp v10, v8 row_half_mirror row_mask:0xf bank_mask:0xf
  v_mov_b32_dpp v11, v9 row_half_mirror row_mask:0xf bank_mask:0xf
  s_waitcnt vmcnt(5)
  buffer_load_dwordx4 v[84:87], v2, s[8:11], s63 offen offset:0 nt
  v_mov_b32_dpp v14, v12 row_half_mirror row_mask:0xf bank_mask:0xf
  v_mov_b32_dpp v15, v13 row_half_mirror row_mask:0xf bank_mask:0xf
  v_add_f32 v24, v24, v26
  v_add_f32 v28, v28, v30
  v_add_f32 v16, v16, v24
  v_add_f32 v16, v16, v28
  v_perm_b32 v20, v132, v128, s50
  v_perm_b32 v21, v140, v136, s50
  s_waitcnt vmcnt(5)
  buffer_load_dwordx4 v[88:91], v1, s[8:11], s63 offen offset:2048 nt
  v_perm_b32 v22, v148, v144, s50
  v_perm_b32 v23, v156, v152, s50
  v_perm_b32 v24, v132, v128, s51
  v_perm_b32 v25, v140, v136, s51
  v_perm_b32 v26, v148, v144, s51
  v_perm_b32 v27, v156, v152, s51
  v_mfma_f32_16x16x32_bf16 v[32:35], v[20:23], v[8:11], v[32:35]
  v_perm_b32 v28, v133, v129, s50
  s_waitcnt vmcnt(5)
  buffer_load_dwordx4 v[92:95], v2, s[8:11], s63 offen offset:2048 nt
  s_mov_b64 exec, 1
  v_mov_b32 v19, 1
  ds_add_u32 v0, v19 offset:96
  s_mov_b64 exec, -1
  v_perm_b32 v29, v141, v137, s50
  v_perm_b32 v30, v149, v145, s50
  v_perm_b32 v31, v157, v153, s50
  v_mfma_f32_16x16x32_bf16 v[36:39], v[24:27], v[8:11], v[36:39]
  v_perm_b32 v20, v133, v129, s51
  v_perm_b32 v21, v141, v137, s51
  v_perm_b32 v22, v149, v145, s51
  v_perm_b32 v23, v157, v153, s51
  s_waitcnt vmcnt(5)
  buffer_load_dwordx4 v[96:99], v1, s[8:11], s64 offen offset:0 nt
  v_mfma_f32_16x16x32_bf16 v[40:43], v[28:31], v[8:11], v[40:43]
  v_perm_b32 v24, v134, v130, s50
  v_perm_b32 v25, v142, v138, s50
  v_perm_b32 v26, v150, v146, s50
  v_perm_b32 v27, v158, v154, s50
  v_mfma_f32_16x16x32_bf16 v[44:47], v[20:23], v[8:11], v[44:47]
  v_perm_b32 v28, v134, v130, s51
  s_waitcnt vmcnt(5)
  buffer_load_dwordx4 v[100:103], v2, s[8:11], s64 offen offset:0 nt
  v_perm_b32 v29, v142, v138, s51
  v_perm_b32 v30, v150, v146, s51
  v_perm_b32 v31, v158, v154, s51
  v_mfma_f32_16x16x32_bf16 v[48:51], v[24:27], v[8:11], v[48:51]
  v_perm_b32 v20, v135, v131, s50
  v_perm_b32 v21, v143, v139, s50
  v_perm_b32 v22, v151, v147, s50
  v_perm_b32 v23, v159, v155, s50
  s_waitcnt vmcnt(5)
  buffer_load_dwordx4 v[104:107], v1, s[8:11], s64 offen offset:2048 nt
  v_mfma_f32_16x16x32_bf16 v[52:55], v[28:31], v[8:11], v[52:55]
  v_perm_b32 v24, v135, v131, s51
  v_perm_b32 v25, v143, v139, s51
  v_perm_b32 v26, v151, v147, s51
  v_perm_b32 v27, v159, v155, s51
  v_mfma_f32_16x16x32_bf16 v[56:59], v[20:23], v[8:11], v[56:59]
  v_perm_b32 v28, v164, v160, s50
  v_perm_b32 v29, v172, v168, s50
  s_waitcnt vmcnt(5)
  buffer_load_dwordx4 v[108:111], v2, s[8:11], s64 offen offset:2048 nt
  v_perm_b32 v30, v180, v176, s50
  v_perm_b32 v31, v188, v184, s50
  v_mfma_f32_16x16x32_bf16 v[60:63], v[24:27], v[8:11], v[60:63]
  v_perm_b32 v20, v164, v160, s51
  v_perm_b32 v21, v172, v168, s51
  v_perm_b32 v22, v180, v176, s51
  v_perm_b32 v23, v188, v184, s51
  v_mfma_f32_16x16x32_bf16 v[32:35], v[28:31], v[12:15], v[32:35]
  s_waitcnt vmcnt(5)
  buffer_load_dwordx4 v[112:115], v1, s[8:11], s65 offen offset:0 nt
  v_perm_b32 v24, v165, v161, s50
  v_perm_b32 v25, v173, v169, s50
  v_perm_b32 v26, v181, v177, s50
  v_perm_b32 v27, v189, v185, s50
  v_mfma_f32_16x16x32_bf16 v[36:39], v[20:23], v[12:15], v[36:39]
  v_perm_b32 v28, v165, v161, s51
  v_perm_b32 v29, v173, v169, s51
  s_waitcnt vmcnt(5)
  buffer_load_dwordx4 v[116:119], v2, s[8:11], s65 offen offset:0 nt
  v_perm_b32 v30, v181, v177, s51
  v_perm_b32 v31, v189, v185, s51
  v_mfma_f32_16x16x32_bf16 v[40:43], v[24:27], v[12:15], v[40:43]
  v_perm_b32 v20, v166, v162, s50
  v_perm_b32 v21, v174, v170, s50
  v_perm_b32 v22, v182, v178, s50
  v_perm_b32 v23, v190, v186, s50
  v_mfma_f32_16x16x32_bf16 v[44:47], v[28:31], v[12:15], v[44:47]
  s_waitcnt vmcnt(5)
  buffer_load_dwordx4 v[120:123], v1, s[8:11], s65 offen offset:2048 nt
  v_perm_b32 v24, v166, v162, s51
  v_perm_b32 v25, v174, v170, s51
  v_perm_b32 v26, v182, v178, s51
  v_perm_b32 v27, v190, v186, s51
  v_mfma_f32_16x16x32_bf16 v[48:51], v[20:23], v[12:15], v[48:51]
  v_perm_b32 v28, v167, v163, s50
  v_perm_b32 v29, v175, v171, s50
  v_perm_b32 v30, v183, v179, s50
  s_waitcnt vmcnt(5)
  buffer_load_dwordx4 v[124:127], v2, s[8:11], s65 offen offset:2048 nt
  s_mov_b64 exec, 1
  v_mov_b32 v19, 1
  ds_add_u32 v0, v19 offset:96
  s_mov_b64 exec, -1
  ds_read_b32 v18, v0 offset:4
  v_perm_b32 v31, v191, v187, s50
  v_mfma_f32_16x16x32_bf16 v[52:55], v[24:27], v[12:15], v[52:55]
  v_perm_b32 v20, v167, v163, s51
  v_perm_b32 v21, v175, v171, s51
  v_perm_b32 v22, v183, v179, s51
  v_perm_b32 v23, v191, v187, s51
  v_mfma_f32_16x16x32_bf16 v[56:59], v[28:31], v[12:15], v[56:59]
  s_nop 0
  v_mfma_f32_16x16x32_bf16 v[60:63], v[20:23], v[12:15], v[60:63]
  s_add_u32 s62, s62, 1048576
  s_add_u32 s63, s63, 1048576
  s_add_u32 s64, s64, 1048576
  s_add_u32 s65, s65, 1048576
  s_add_u32 s61, s61, 1
  s_waitcnt lgkmcnt(0)
  v_readfirstlane_b32 s66, v18
  s_cmp_eq_u32 s61, 14
  s_cbranch_scc1 L_n2
  s_lshl_b32 s67, s61, 5
  s_cmp_eq_u32 s66, 0
  s_cselect_b32 s66, s67, s66
  s_sub_i32 s66, s66, s67
  s_cmp_ge_u32 s61, 13
  s_cselect_b32 s67, 64, 0
  s_add_i32 s66, s66, s67
  s_cmp_ge_i32 s66, 8
  s_cbranch_scc1 L_VB2
  s_cmp_lt_i32 s66, -6
  s_cbranch_scc1 L_VS2
  s_branch L_VN2
L_VB2:
  s_waitcnt vmcnt(7)
  buffer_load_dwordx4 v[128:131], v1, s[8:11], s62 offen offset:0 nt
  ds_read_b64 v[20:21], v4 offset:0
  ds_read_b64 v[22:23], v4 offset:512
  v_add_u32 v4, 1024, v4
  s_waitcnt lgkmcnt(0)
  v_lshlrev_b32 v24, 16, v20
  v_and_b32 v25, 0xffff0000, v20
  v_lshlrev_b32 v26, 16, v21
  s_waitcnt vmcnt(7)
  buffer_load_dwordx4 v[132:135], v2, s[8:11], s62 offen offset:0 nt
  v_and_b32 v27, 0xffff0000, v21
  v_lshlrev_b32 v28, 16, v22
  v_and_b32 v29, 0xffff0000, v22
  v_lshlrev_b32 v30, 16, v23
  v_and_b32 v31, 0xffff0000, v23
  v_fma_f32 v24, v24, s53, -v3
  v_fma_f32 v25, v25, s53, -v3
  v_fma_f32 v26, v26, s53, -v3
  s_waitcnt vmcnt(7)
  buffer_load_dwordx4 v[136:139], v1, s[8:11], s62 offen offset:2048 nt
  v_fma_f32 v27, v27, s53, -v3
  v_fma_f32 v28, v28, s53, -v3
  v_fma_f32 v29, v29, s53, -v3
  v_fma_f32 v30, v30, s53, -v3
  v_fma_f32 v31, v31, s53, -v3
  v_exp_f32 v24, v24
  v_exp_f32 v25, v25
  v_exp_f32 v26, v26
  s_waitcnt vmcnt(7)
  buffer_load_dwordx4 v[140:143], v2, s[8:11], s62 offen offset:2048 nt
  v_exp_f32 v27, v27
  v_exp_f32 v28, v28
  v_exp_f32 v29, v29
  v_exp_f32 v30, v30
  v_exp_f32 v31, v31
  v_cvt_pk_bf16_f32 v8, v24, v25
  v_cvt_pk_bf16_f32 v9, v26, v27
  v_cvt_pk_bf16_f32 v12, v28, v29
  s_waitcnt vmcnt(7)
  buffer_load_dwordx4 v[144:147], v1, s[8:11], s63 offen offset:0 nt
  v_cvt_pk_bf16_f32 v13, v30, v31
  v_add_f32 v24, v24, v25
  v_add_f32 v26, v26, v27
  v_add_f32 v28, v28, v29
  v_add_f32 v30, v30, v31
  v_mov_b32_dpp v10, v8 row_half_mirror row_mask:0xf bank_mask:0xf
  v_mov_b32_dpp v11, v9 row_half_mirror row_mask:0xf bank_mask:0xf
  s_waitcnt vmcnt(7)
  buffer_load_dwordx4 v[148:151], v2, s[8:11], s63 offen offset:0 nt
  v_mov_b32_dpp v14, v12 row_half_mirror row_mask:0xf bank_mask:0xf
  v_mov_b32_dpp v15, v13 row_half_mirror row_mask:0xf bank_mask:0xf
  v_add_f32 v24, v24, v26
  v_add_f32 v28, v28, v30
  v_add_f32 v16, v16, v24
  v_add_f32 v16, v16, v28
  v_perm_b32 v20, v196, v192, s50
  v_perm_b32 v21, v204, v200, s50
  s_waitcnt vmcnt(7)
  buffer_load_dwordx4 v[152:155], v1, s[8:11], s63 offen offset:2048 nt
  v_perm_b32 v22, v212, v208, s50
  v_perm_b32 v23, v220, v216, s50
  v_perm_b32 v24, v196, v192, s51
  v_perm_b32 v25, v204, v200, s51
  v_perm_b32 v26, v212, v208, s51
  v_perm_b32 v27, v220, v216, s51
  v_mfma_f32_16x16x32_bf16 v[32:35], v[20:23], v[8:11], v[32:35]
  v_perm_b32 v28, v197, v193, s50
  s_waitcnt vmcnt(7)
  buffer_load_dwordx4 v[156:159], v2, s[8:11], s63 offen offset:2048 nt
  s_mov_b64 exec, 1
  v_mov_b32 v19, 1
  ds_add_u32 v0, v19 offset:96
  s_mov_b64 exec, -1
  v_perm_b32 v29, v205, v201, s50
  v_perm_b32 v30, v213, v209, s50
  v_perm_b32 v31, v221, v217, s50
  v_mfma_f32_16x16x32_bf16 v[36:39], v[24:27], v[8:11], v[36:39]
  v_perm_b32 v20, v197, v193, s51
  v_perm_b32 v21, v205, v201, s51
  v_perm_b32 v22, v213, v209, s51
  v_perm_b32 v23, v221, v217, s51
  s_waitcnt vmcnt(7)
  buffer_load_dwordx4 v[160:163], v1, s[8:11], s64 offen offset:0 nt
  v_mfma_f32_16x16x32_bf16 v[40:43], v[28:31], v[8:11], v[40:43]
  v_perm_b32 v24, v198, v194, s50
  v_perm_b32 v25, v206, v202, s50
  v_perm_b32 v26, v214, v210, s50
  v_perm_b32 v27, v222, v218, s50
  v_mfma_f32_16x16x32_bf16 v[44:47], v[20:23], v[8:11], v[44:47]
  v_perm_b32 v28, v198, v194, s51
  s_waitcnt vmcnt(7)
  buffer_load_dwordx4 v[164:167], v2, s[8:11], s64 offen offset:0 nt
  v_perm_b32 v29, v206, v202, s51
  v_perm_b32 v30, v214, v210, s51
  v_perm_b32 v31, v222, v218, s51
  v_mfma_f32_16x16x32_bf16 v[48:51], v[24:27], v[8:11], v[48:51]
  v_perm_b32 v20, v199, v195, s50
  v_perm_b32 v21, v207, v203, s50
  v_perm_b32 v22, v215, v211, s50
  v_perm_b32 v23, v223, v219, s50
  s_waitcnt vmcnt(7)
  buffer_load_dwordx4 v[168:171], v1, s[8:11], s64 offen offset:2048 nt
  v_mfma_f32_16x16x32_bf16 v[52:55], v[28:31], v[8:11], v[52:55]
  v_perm_b32 v24, v199, v195, s51
  v_perm_b32 v25, v207, v203, s51
  v_perm_b32 v26, v215, v211, s51
  v_perm_b32 v27, v223, v219, s51
  v_mfma_f32_16x16x32_bf16 v[56:59], v[20:23], v[8:11], v[56:59]
  v_perm_b32 v28, v228, v224, s50
  v_perm_b32 v29, v236, v232, s50
  s_waitcnt vmcnt(7)
  buffer_load_dwordx4 v[172:175], v2, s[8:11], s64 offen offset:2048 nt
  v_perm_b32 v30, v244, v240, s50
  v_perm_b32 v31, v252, v248, s50
  v_mfma_f32_16x16x32_bf16 v[60:63], v[24:27], v[8:11], v[60:63]
  v_perm_b32 v20, v228, v224, s51
  v_perm_b32 v21, v236, v232, s51
  v_perm_b32 v22, v244, v240, s51
  v_perm_b32 v23, v252, v248, s51
  v_mfma_f32_16x16x32_bf16 v[32:35], v[28:31], v[12:15], v[32:35]
  s_waitcnt vmcnt(7)
  buffer_load_dwordx4 v[176:179], v1, s[8:11], s65 offen offset:0 nt
  v_perm_b32 v24, v229, v225, s50
  v_perm_b32 v25, v237, v233, s50
  v_perm_b32 v26, v245, v241, s50
  v_perm_b32 v27, v253, v249, s50
  v_mfma_f32_16x16x32_bf16 v[36:39], v[20:23], v[12:15], v[36:39]
  v_perm_b32 v28, v229, v225, s51
  v_perm_b32 v29, v237, v233, s51
  s_waitcnt vmcnt(7)
  buffer_load_dwordx4 v[180:183], v2, s[8:11], s65 offen offset:0 nt
  v_perm_b32 v30, v245, v241, s51
  v_perm_b32 v31, v253, v249, s51
  v_mfma_f32_16x16x32_bf16 v[40:43], v[24:27], v[12:15], v[40:43]
  v_perm_b32 v20, v230, v226, s50
  v_perm_b32 v21, v238, v234, s50
  v_perm_b32 v22, v246, v242, s50
  v_perm_b32 v23, v254, v250, s50
  v_mfma_f32_16x16x32_bf16 v[44:47], v[28:31], v[12:15], v[44:47]
  s_waitcnt vmcnt(7)
  buffer_load_dwordx4 v[184:187], v1, s[8:11], s65 offen offset:2048 nt
  v_perm_b32 v24, v230, v226, s51
  v_perm_b32 v25, v238, v234, s51
  v_perm_b32 v26, v246, v242, s51
  v_perm_b32 v27, v254, v250, s51
  v_mfma_f32_16x16x32_bf16 v[48:51], v[20:23], v[12:15], v[48:51]
  v_perm_b32 v28, v231, v227, s50
  v_perm_b32 v29, v239, v235, s50
  v_perm_b32 v30, v247, v243, s50
  s_waitcnt vmcnt(7)
  buffer_load_dwordx4 v[188:191], v2, s[8:11], s65 offen offset:2048 nt
  s_mov_b64 exec, 1
  v_mov_b32 v19, 1
  ds_add_u32 v0, v19 offset:96
  s_mov_b64 exec, -1
  ds_read_b32 v18, v0 offset:4
  v_perm_b32 v31, v255, v251, s50
  v_mfma_f32_16x16x32_bf16 v[52:55], v[24:27], v[12:15], v[52:55]
  v_perm_b32 v20, v231, v227, s51
  v_perm_b32 v21, v239, v235, s51
  v_perm_b32 v22, v247, v243, s51
  v_perm_b32 v23, v255, v251, s51
  v_mfma_f32_16x16x32_bf16 v[56:59], v[28:31], v[12:15], v[56:59]
  s_nop 0
  v_mfma_f32_16x16x32_bf16 v[60:63], v[20:23], v[12:15], v[60:63]
  s_add_u32 s62, s62, 1048576
  s_add_u32 s63, s63, 1048576
  s_add_u32 s64, s64, 1048576
  s_add_u32 s65, s65, 1048576
  s_add_u32 s61, s61, 1
  s_waitcnt lgkmcnt(0)
  v_readfirstlane_b32 s66, v18
  s_lshl_b32 s67, s61, 5
  s_cmp_eq_u32 s66, 0
  s_cselect_b32 s66, s67, s66
  s_sub_i32 s66, s66, s67
  s_cmp_ge_u32 s61, 13
  s_cselect_b32 s67, 64, 0
  s_add_i32 s66, s66, s67
  s_cmp_lt_i32 s66, -6
  s_cbranch_scc1 L_VS0
  s_cmp_lt_i32 s66, 8
  s_cbranch_scc1 L_VN0
L_VB0:
  s_waitcnt vmcnt(7)
  buffer_load_dwordx4 v[192:195], v1, s[8:11], s62 offen offset:0 nt
  ds_read_b64 v[20:21], v4 offset:0
  ds_read_b64 v[22:23], v4 offset:512
  v_add_u32 v4, 1024, v4
  s_waitcnt lgkmcnt(0)
  v_lshlrev_b32 v24, 16, v20
  v_and_b32 v25, 0xffff0000, v20
  v_lshlrev_b32 v26, 16, v21
  s_waitcnt vmcnt(7)
  buffer_load_dwordx4 v[196:199], v2, s[8:11], s62 offen offset:0 nt
  v_and_b32 v27, 0xffff0000, v21
  v_lshlrev_b32 v28, 16, v22
  v_and_b32 v29, 0xffff0000, v22
  v_lshlrev_b32 v30, 16, v23
  v_and_b32 v31, 0xffff0000, v23
  v_fma_f32 v24, v24, s53, -v3
  v_fma_f32 v25, v25, s53, -v3
  v_fma_f32 v26, v26, s53, -v3
  s_waitcnt vmcnt(7)
  buffer_load_dwordx4 v[200:203], v1, s[8:11], s62 offen offset:2048 nt
  v_fma_f32 v27, v27, s53, -v3
  v_fma_f32 v28, v28, s53, -v3
  v_fma_f32 v29, v29, s53, -v3
  v_fma_f32 v30, v30, s53, -v3
  v_fma_f32 v31, v31, s53, -v3
  v_exp_f32 v24, v24
  v_exp_f32 v25, v25
  v_exp_f32 v26, v26
  s_waitcnt vmcnt(7)
  buffer_load_dwordx4 v[204:207], v2, s[8:11], s62 offen offset:2048 nt
  v_exp_f32 v27, v27
  v_exp_f32 v28, v28
  v_exp_f32 v29, v29
  v_exp_f32 v30, v30
  v_exp_f32 v31, v31
  v_cvt_pk_bf16_f32 v8, v24, v25
  v_cvt_pk_bf16_f32 v9, v26, v27
  v_cvt_pk_bf16_f32 v12, v28, v29
  s_waitcnt vmcnt(7)
  buffer_load_dwordx4 v[208:211], v1, s[8:11], s63 offen offset:0 nt
  v_cvt_pk_bf16_f32 v13, v30, v31
  v_add_f32 v24, v24, v25
  v_add_f32 v26, v26, v27
  v_add_f32 v28, v28, v29
  v_add_f32 v30, v30, v31
  v_mov_b32_dpp v10, v8 row_half_mirror row_mask:0xf bank_mask:0xf
  v_mov_b32_dpp v11, v9 row_half_mirror row_mask:0xf bank_mask:0xf
  s_waitcnt vmcnt(7)
  buffer_load_dwordx4 v[212:215], v2, s[8:11], s63 offen offset:0 nt
  v_mov_b32_dpp v14, v12 row_half_mirror row_mask:0xf bank_mask:0xf
  v_mov_b32_dpp v15, v13 row_half_mirror row_mask:0xf bank_mask:0xf
  v_add_f32 v24, v24, v26
  v_add_f32 v28, v28, v30
  v_add_f32 v16, v16, v24
  v_add_f32 v16, v16, v28
  v_perm_b32 v20, v68, v64, s50
  v_perm_b32 v21, v76, v72, s50
  s_waitcnt vmcnt(7)
  buffer_load_dwordx4 v[216:219], v1, s[8:11], s63 offen offset:2048 nt
  v_perm_b32 v22, v84, v80, s50
  v_perm_b32 v23, v92, v88, s50
  v_perm_b32 v24, v68, v64, s51
  v_perm_b32 v25, v76, v72, s51
  v_perm_b32 v26, v84, v80, s51
  v_perm_b32 v27, v92, v88, s51
  v_mfma_f32_16x16x32_bf16 v[32:35], v[20:23], v[8:11], v[32:35]
  v_perm_b32 v28, v69, v65, s50
  s_waitcnt vmcnt(7)
  buffer_load_dwordx4 v[220:223], v2, s[8:11], s63 offen offset:2048 nt
  s_mov_b64 exec, 1
  v_mov_b32 v19, 1
  ds_add_u32 v0, v19 offset:96
  s_mov_b64 exec, -1
  v_perm_b32 v29, v77, v73, s50
  v_perm_b32 v30, v85, v81, s50
  v_perm_b32 v31, v93, v89, s50
  v_mfma_f32_16x16x32_bf16 v[36:39], v[24:27], v[8:11], v[36:39]
  v_perm_b32 v20, v69, v65, s51
  v_perm_b32 v21, v77, v73, s51
  v_perm_b32 v22, v85, v81, s51
  v_perm_b32 v23, v93, v89, s51
  s_waitcnt vmcnt(7)
  buffer_load_dwordx4 v[224:227], v1, s[8:11], s64 offen offset:0 nt
  v_mfma_f32_16x16x32_bf16 v[40:43], v[28:31], v[8:11], v[40:43]
  v_perm_b32 v24, v70, v66, s50
  v_perm_b32 v25, v78, v74, s50
  v_perm_b32 v26, v86, v82, s50
  v_perm_b32 v27, v94, v90, s50
  v_mfma_f32_16x16x32_bf16 v[44:47], v[20:23], v[8:11], v[44:47]
  v_perm_b32 v28, v70, v66, s51
  s_waitcnt vmcnt(7)
  buffer_load_dwordx4 v[228:231], v2, s[8:11], s64 offen offset:0 nt
  v_perm_b32 v29, v78, v74, s51
  v_perm_b32 v30, v86, v82, s51
  v_perm_b32 v31, v94, v90, s51
  v_mfma_f32_16x16x32_bf16 v[48:51], v[24:27], v[8:11], v[48:51]
  v_perm_b32 v20, v71, v67, s50
  v_perm_b32 v21, v79, v75, s50
  v_perm_b32 v22, v87, v83, s50
  v_perm_b32 v23, v95, v91, s50
  s_waitcnt vmcnt(7)
  buffer_load_dwordx4 v[232:235], v1, s[8:11], s64 offen offset:2048 nt
  v_mfma_f32_16x16x32_bf16 v[52:55], v[28:31], v[8:11], v[52:55]
  v_perm_b32 v24, v71, v67, s51
  v_perm_b32 v25, v79, v75, s51
  v_perm_b32 v26, v87, v83, s51
  v_perm_b32 v27, v95, v91, s51
  v_mfma_f32_16x16x32_bf16 v[56:59], v[20:23], v[8:11], v[56:59]
  v_perm_b32 v28, v100, v96, s50
  v_perm_b32 v29, v108, v104, s50
  s_waitcnt vmcnt(7)
  buffer_load_dwordx4 v[236:239], v2, s[8:11], s64 offen offset:2048 nt
  v_perm_b32 v30, v116, v112, s50
  v_perm_b32 v31, v124, v120, s50
  v_mfma_f32_16x16x32_bf16 v[60:63], v[24:27], v[8:11], v[60:63]
  v_perm_b32 v20, v100, v96, s51
  v_perm_b32 v21, v108, v104, s51
  v_perm_b32 v22, v116, v112, s51
  v_perm_b32 v23, v124, v120, s51
  v_mfma_f32_16x16x32_bf16 v[32:35], v[28:31], v[12:15], v[32:35]
  s_waitcnt vmcnt(7)
  buffer_load_dwordx4 v[240:243], v1, s[8:11], s65 offen offset:0 nt
  v_perm_b32 v24, v101, v97, s50
  v_perm_b32 v25, v109, v105, s50
  v_perm_b32 v26, v117, v113, s50
  v_perm_b32 v27, v125, v121, s50
  v_mfma_f32_16x16x32_bf16 v[36:39], v[20:23], v[12:15], v[36:39]
  v_perm_b32 v28, v101, v97, s51
  v_perm_b32 v29, v109, v105, s51
  s_waitcnt vmcnt(7)
  buffer_load_dwordx4 v[244:247], v2, s[8:11], s65 offen offset:0 nt
  v_perm_b32 v30, v117, v113, s51
  v_perm_b32 v31, v125, v121, s51
  v_mfma_f32_16x16x32_bf16 v[40:43], v[24:27], v[12:15], v[40:43]
  v_perm_b32 v20, v102, v98, s50
  v_perm_b32 v21, v110, v106, s50
  v_perm_b32 v22, v118, v114, s50
  v_perm_b32 v23, v126, v122, s50
  v_mfma_f32_16x16x32_bf16 v[44:47], v[28:31], v[12:15], v[44:47]
  s_waitcnt vmcnt(7)
  buffer_load_dwordx4 v[248:251], v1, s[8:11], s65 offen offset:2048 nt
  v_perm_b32 v24, v102, v98, s51
  v_perm_b32 v25, v110, v106, s51
  v_perm_b32 v26, v118, v114, s51
  v_perm_b32 v27, v126, v122, s51
  v_mfma_f32_16x16x32_bf16 v[48:51], v[20:23], v[12:15], v[48:51]
  v_perm_b32 v28, v103, v99, s50
  v_perm_b32 v29, v111, v107, s50
  v_perm_b32 v30, v119, v115, s50
  s_waitcnt vmcnt(7)
  buffer_load_dwordx4 v[252:255], v2, s[8:11], s65 offen offset:2048 nt
  s_mov_b64 exec, 1
  v_mov_b32 v19, 1
  ds_add_u32 v0, v19 offset:96
  s_mov_b64 exec, -1
  ds_read_b32 v18, v0 offset:4
  v_perm_b32 v31, v127, v123, s50
  v_mfma_f32_16x16x32_bf16 v[52:55], v[24:27], v[12:15], v[52:55]
  v_perm_b32 v20, v103, v99, s51
  v_perm_b32 v21, v111, v107, s51
  v_perm_b32 v22, v119, v115, s51
  v_perm_b32 v23, v127, v123, s51
  v_mfma_f32_16x16x32_bf16 v[56:59], v[28:31], v[12:15], v[56:59]
  s_nop 0
  v_mfma_f32_16x16x32_bf16 v[60:63], v[20:23], v[12:15], v[60:63]
  s_add_u32 s62, s62, 1048576
  s_add_u32 s63, s63, 1048576
  s_add_u32 s64, s64, 1048576
  s_add_u32 s65, s65, 1048576
  s_add_u32 s61, s61, 1
  s_waitcnt lgkmcnt(0)
  v_readfirstlane_b32 s66, v18
  s_lshl_b32 s67, s61, 5
  s_cmp_eq_u32 s66, 0
  s_cselect_b32 s66, s67, s66
  s_sub_i32 s66, s66, s67
  s_cmp_ge_u32 s61, 13
  s_cselect_b32 s67, 64, 0
  s_add_i32 s66, s66, s67
  s_cmp_lt_i32 s66, -6
  s_cbranch_scc1 L_VS1
  s_cmp_lt_i32 s66, 8
  s_cbranch_scc1 L_VN1
L_VB1:
  s_waitcnt vmcnt(7)
  buffer_load_dwordx4 v[64:67], v1, s[8:11], s62 offen offset:0 nt
  ds_read_b64 v[20:21], v4 offset:0
  ds_read_b64 v[22:23], v4 offset:512
  v_add_u32 v4, 1024, v4
  s_waitcnt lgkmcnt(0)
  v_lshlrev_b32 v24, 16, v20
  v_and_b32 v25, 0xffff0000, v20
  v_lshlrev_b32 v26, 16, v21
  s_waitcnt vmcnt(7)
  buffer_load_dwordx4 v[68:71], v2, s[8:11], s62 offen offset:0 nt
  v_and_b32 v27, 0xffff0000, v21
  v_lshlrev_b32 v28, 16, v22
  v_and_b32 v29, 0xffff0000, v22
  v_lshlrev_b32 v30, 16, v23
  v_and_b32 v31, 0xffff0000, v23
  v_fma_f32 v24, v24, s53, -v3
  v_fma_f32 v25, v25, s53, -v3
  v_fma_f32 v26, v26, s53, -v3
  s_waitcnt vmcnt(7)
  buffer_load_dwordx4 v[72:75], v1, s[8:11], s62 offen offset:2048 nt
  v_fma_f32 v27, v27, s53, -v3
  v_fma_f32 v28, v28, s53, -v3
  v_fma_f32 v29, v29, s53, -v3
  v_fma_f32 v30, v30, s53, -v3
  v_fma_f32 v31, v31, s53, -v3
  v_exp_f32 v24, v24
  v_exp_f32 v25, v25
  v_exp_f32 v26, v26
  s_waitcnt vmcnt(7)
  buffer_load_dwordx4 v[76:79], v2, s[8:11], s62 offen offset:2048 nt
  v_exp_f32 v27, v27
  v_exp_f32 v28, v28
  v_exp_f32 v29, v29
  v_exp_f32 v30, v30
  v_exp_f32 v31, v31
  v_cvt_pk_bf16_f32 v8, v24, v25
  v_cvt_pk_bf16_f32 v9, v26, v27
  v_cvt_pk_bf16_f32 v12, v28, v29
  s_waitcnt vmcnt(7)
  buffer_load_dwordx4 v[80:83], v1, s[8:11], s63 offen offset:0 nt
  v_cvt_pk_bf16_f32 v13, v30, v31
  v_add_f32 v24, v24, v25
  v_add_f32 v26, v26, v27
  v_add_f32 v28, v28, v29
  v_add_f32 v30, v30, v31
  v_mov_b32_dpp v10, v8 row_half_mirror row_mask:0xf bank_mask:0xf
  v_mov_b32_dpp v11, v9 row_half_mirror row_mask:0xf bank_mask:0xf
  s_waitcnt vmcnt(7)
  buffer_load_dwordx4 v[84:87], v2, s[8:11], s63 offen offset:0 nt
  v_mov_b32_dpp v14, v12 row_half_mirror row_mask:0xf bank_mask:0xf
  v_mov_b32_dpp v15, v13 row_half_mirror row_mask:0xf bank_mask:0xf
  v_add_f32 v24, v24, v26
  v_add_f32 v28, v28, v30
  v_add_f32 v16, v16, v24
  v_add_f32 v16, v16, v28
  v_perm_b32 v20, v132, v128, s50
  v_perm_b32 v21, v140, v136, s50
  s_waitcnt vmcnt(7)
  buffer_load_dwordx4 v[88:91], v1, s[8:11], s63 offen offset:2048 nt
  v_perm_b32 v22, v148, v144, s50
  v_perm_b32 v23, v156, v152, s50
  v_perm_b32 v24, v132, v128, s51
  v_perm_b32 v25, v140, v136, s51
  v_perm_b32 v26, v148, v144, s51
  v_perm_b32 v27, v156, v152, s51
  v_mfma_f32_16x16x32_bf16 v[32:35], v[20:23], v[8:11], v[32:35]
  v_perm_b32 v28, v133, v129, s50
  s_waitcnt vmcnt(7)
  buffer_load_dwordx4 v[92:95], v2, s[8:11], s63 offen offset:2048 nt
  s_mov_b64 exec, 1
  v_mov_b32 v19, 1
  ds_add_u32 v0, v19 offset:96
  s_mov_b64 exec, -1
  v_perm_b32 v29, v141, v137, s50
  v_perm_b32 v30, v149, v145, s50
  v_perm_b32 v31, v157, v153, s50
  v_mfma_f32_16x16x32_bf16 v[36:39], v[24:27], v[8:11], v[36:39]
  v_perm_b32 v20, v133, v129, s51
  v_perm_b32 v21, v141, v137, s51
  v_perm_b32 v22, v149, v145, s51
  v_perm_b32 v23, v157, v153, s51
  s_waitcnt vmcnt(7)
  buffer_load_dwordx4 v[96:99], v1, s[8:11], s64 offen offset:0 nt
  v_mfma_f32_16x16x32_bf16 v[40:43], v[28:31], v[8:11], v[40:43]
  v_perm_b32 v24, v134, v130, s50
  v_perm_b32 v25, v142, v138, s50
  v_perm_b32 v26, v150, v146, s50
  v_perm_b32 v27, v158, v154, s50
  v_mfma_f32_16x16x32_bf16 v[44:47], v[20:23], v[8:11], v[44:47]
  v_perm_b32 v28, v134, v130, s51
  s_waitcnt vmcnt(7)
  buffer_load_dwordx4 v[100:103], v2, s[8:11], s64 offen offset:0 nt
  v_perm_b32 v29, v142, v138, s51
  v_perm_b32 v30, v150, v146, s51
  v_perm_b32 v31, v158, v154, s51
  v_mfma_f32_16x16x32_bf16 v[48:51], v[24:27], v[8:11], v[48:51]
  v_perm_b32 v20, v135, v131, s50
  v_perm_b32 v21, v143, v139, s50
  v_perm_b32 v22, v151, v147, s50
  v_perm_b32 v23, v159, v155, s50
  s_waitcnt vmcnt(7)
  buffer_load_dwordx4 v[104:107], v1, s[8:11], s64 offen offset:2048 nt
  v_mfma_f32_16x16x32_bf16 v[52:55], v[28:31], v[8:11], v[52:55]
  v_perm_b32 v24, v135, v131, s51
  v_perm_b32 v25, v143, v139, s51
  v_perm_b32 v26, v151, v147, s51
  v_perm_b32 v27, v159, v155, s51
  v_mfma_f32_16x16x32_bf16 v[56:59], v[20:23], v[8:11], v[56:59]
  v_perm_b32 v28, v164, v160, s50
  v_perm_b32 v29, v172, v168, s50
  s_waitcnt vmcnt(7)
  buffer_load_dwordx4 v[108:111], v2, s[8:11], s64 offen offset:2048 nt
  v_perm_b32 v30, v180, v176, s50
  v_perm_b32 v31, v188, v184, s50
  v_mfma_f32_16x16x32_bf16 v[60:63], v[24:27], v[8:11], v[60:63]
  v_perm_b32 v20, v164, v160, s51
  v_perm_b32 v21, v172, v168, s51
  v_perm_b32 v22, v180, v176, s51
  v_perm_b32 v23, v188, v184, s51
  v_mfma_f32_16x16x32_bf16 v[32:35], v[28:31], v[12:15], v[32:35]
  s_waitcnt vmcnt(7)
  buffer_load_dwordx4 v[112:115], v1, s[8:11], s65 offen offset:0 nt
  v_perm_b32 v24, v165, v161, s50
  v_perm_b32 v25, v173, v169, s50
  v_perm_b32 v26, v181, v177, s50
  v_perm_b32 v27, v189, v185, s50
  v_mfma_f32_16x16x32_bf16 v[36:39], v[20:23], v[12:15], v[36:39]
  v_perm_b32 v28, v165, v161, s51
  v_perm_b32 v29, v173, v169, s51
  s_waitcnt vmcnt(7)
  buffer_load_dwordx4 v[116:119], v2, s[8:11], s65 offen offset:0 nt
  v_perm_b32 v30, v181, v177, s51
  v_perm_b32 v31, v189, v185, s51
  v_mfma_f32_16x16x32_bf16 v[40:43], v[24:27], v[12:15], v[40:43]
  v_perm_b32 v20, v166, v162, s50
  v_perm_b32 v21, v174, v170, s50
  v_perm_b32 v22, v182, v178, s50
  v_perm_b32 v23, v190, v186, s50
  v_mfma_f32_16x16x32_bf16 v[44:47], v[28:31], v[12:15], v[44:47]
  s_waitcnt vmcnt(7)
  buffer_load_dwordx4 v[120:123], v1, s[8:11], s65 offen offset:2048 nt
  v_perm_b32 v24, v166, v162, s51
  v_perm_b32 v25, v174, v170, s51
  v_perm_b32 v26, v182, v178, s51
  v_perm_b32 v27, v190, v186, s51
  v_mfma_f32_16x16x32_bf16 v[48:51], v[20:23], v[12:15], v[48:51]
  v_perm_b32 v28, v167, v163, s50
  v_perm_b32 v29, v175, v171, s50
  v_perm_b32 v30, v183, v179, s50
  s_waitcnt vmcnt(7)
  buffer_load_dwordx4 v[124:127], v2, s[8:11], s65 offen offset:2048 nt
  s_mov_b64 exec, 1
  v_mov_b32 v19, 1
  ds_add_u32 v0, v19 offset:96
  s_mov_b64 exec, -1
  ds_read_b32 v18, v0 offset:4
  v_perm_b32 v31, v191, v187, s50
  v_mfma_f32_16x16x32_bf16 v[52:55], v[24:27], v[12:15], v[52:55]
  v_perm_b32 v20, v167, v163, s51
  v_perm_b32 v21, v175, v171, s51
  v_perm_b32 v22, v183, v179, s51
  v_perm_b32 v23, v191, v187, s51
  v_mfma_f32_16x16x32_bf16 v[56:59], v[28:31], v[12:15], v[56:59]
  s_nop 0
  v_mfma_f32_16x16x32_bf16 v[60:63], v[20:23], v[12:15], v[60:63]
  s_add_u32 s62, s62, 1048576
  s_add_u32 s63, s63, 1048576
  s_add_u32 s64, s64, 1048576
  s_add_u32 s65, s65, 1048576
  s_add_u32 s61, s61, 1
  s_waitcnt lgkmcnt(0)
  v_readfirstlane_b32 s66, v18
  s_cmp_eq_u32 s61, 14
  s_cbranch_scc1 L_n2
  s_lshl_b32 s67, s61, 5
  s_cmp_eq_u32 s66, 0
  s_cselect_b32 s66, s67, s66
  s_sub_i32 s66, s66, s67
  s_cmp_ge_u32 s61, 13
  s_cselect_b32 s67, 64, 0
  s_add_i32 s66, s66, s67
  s_cmp_lt_i32 s66, -6
  s_cbranch_scc1 L_VS2
  s_cmp_lt_i32 s66, 8
  s_cbranch_scc1 L_VN2
  s_branch L_VB2
L_VS2:
  s_waitcnt vmcnt(4)
  buffer_load_dwordx4 v[128:131], v1, s[8:11], s62 offen offset:0 nt
  ds_read_b64 v[20:21], v4 offset:0
  ds_read_b64 v[22:23], v4 offset:512
  v_add_u32 v4, 1024, v4
  s_waitcnt lgkmcnt(0)
  v_lshlrev_b32 v24, 16, v20
  v_and_b32 v25, 0xffff0000, v20
  v_lshlrev_b32 v26, 16, v21
  s_waitcnt vmcnt(4)
  buffer_load_dwordx4 v[132:135], v2, s[8:11], s62 offen offset:0 nt
  v_and_b32 v27, 0xffff0000, v21
  v_lshlrev_b32 v28, 16, v22
  v_and_b32 v29, 0xffff0000, v22
  v_lshlrev_b32 v30, 16, v23
  v_and_b32 v31, 0xffff0000, v23
  v_fma_f32 v24, v24, s53, -v3
  v_fma_f32 v25, v25, s53, -v3
  v_fma_f32 v26, v26, s53, -v3
  s_waitcnt vmcnt(4)
  buffer_load_dwordx4 v[136:139], v1, s[8:11], s62 offen offset:2048 nt
  v_fma_f32 v27, v27, s53, -v3
  v_fma_f32 v28, v28, s53, -v3
  v_fma_f32 v29, v29, s53, -v3
  v_fma_f32 v30, v30, s53, -v3
  v_fma_f32 v31, v31, s53, -v3
  v_exp_f32 v24, v24
  v_exp_f32 v25, v25
  v_exp_f32 v26, v26
  s_waitcnt vmcnt(4)
  buffer_load_dwordx4 v[140:143], v2, s[8:11], s62 offen offset:2048 nt
  v_exp_f32 v27, v27
  v_exp_f32 v28, v28
  v_exp_f32 v29, v29
  v_exp_f32 v30, v30
  v_exp_f32 v31, v31
  v_cvt_pk_bf16_f32 v8, v24, v25
  v_cvt_pk_bf16_f32 v9, v26, v27
  v_cvt_pk_bf16_f32 v12, v28, v29
  s_waitcnt vmcnt(4)
  buffer_load_dwordx4 v[144:147], v1, s[8:11], s63 offen offset:0 nt
  v_cvt_pk_bf16_f32 v13, v30, v31
  v_add_f32 v24, v24, v25
  v_add_f32 v26, v26, v27
  v_add_f32 v28, v28, v29
  v_add_f32 v30, v30, v31
  v_mov_b32_dpp v10, v8 row_half_mirror row_mask:0xf bank_mask:0xf
  v_mov_b32_dpp v11, v9 row_half_mirror row_mask:0xf bank_mask:0xf
  s_waitcnt vmcnt(4)
  buffer_load_dwordx4 v[148:151], v2, s[8:11], s63 offen offset:0 nt
  v_mov_b32_dpp v14, v12 row_half_mirror row_mask:0xf bank_mask:0xf
  v_mov_b32_dpp v15, v13 row_half_mirror row_mask:0xf bank_mask:0xf
  v_add_f32 v24, v24, v26
  v_add_f32 v28, v28, v30
  v_add_f32 v16, v16, v24
  v_add_f32 v16, v16, v28
  v_perm_b32 v20, v196, v192, s50
  v_perm_b32 v21, v204, v200, s50
  s_waitcnt vmcnt(4)
  buffer_load_dwordx4 v[152:155], v1, s[8:11], s63 offen offset:2048 nt
  v_perm_b32 v22, v212, v208, s50
  v_perm_b32 v23, v220, v216, s50
  v_perm_b32 v24, v196, v192, s51
  v_perm_b32 v25, v204, v200, s51
  v_perm_b32 v26, v212, v208, s51
  v_perm_b32 v27, v220, v216, s51
  v_mfma_f32_16x16x32_bf16 v[32:35], v[20:23], v[8:11], v[32:35]
  v_perm_b32 v28, v197, v193, s50
  s_waitcnt vmcnt(4)
  buffer_load_dwordx4 v[156:159], v2, s[8:11], s63 offen offset:2048 nt
  s_mov_b64 exec, 1
  v_mov_b32 v19, 1
  ds_add_u32 v0, v19 offset:96
  s_mov_b64 exec, -1
  v_perm_b32 v29, v205, v201, s50
  v_perm_b32 v30, v213, v209, s50
  v_perm_b32 v31, v221, v217, s50
  v_mfma_f32_16x16x32_bf16 v[36:39], v[24:27], v[8:11], v[36:39]
  v_perm_b32 v20, v197, v193, s51
  v_perm_b32 v21, v205, v201, s51
  v_perm_b32 v22, v213, v209, s51
  v_perm_b32 v23, v221, v217, s51
  s_waitcnt vmcnt(4)
  buffer_load_dwordx4 v[160:163], v1, s[8:11], s64 offen offset:0 nt
  v_mfma_f32_16x16x32_bf16 v[40:43], v[28:31], v[8:11], v[40:43]
  v_perm_b32 v24, v198, v194, s50
  v_perm_b32 v25, v206, v202, s50
  v_perm_b32 v26, v214, v210, s50
  v_perm_b32 v27, v222, v218, s50
  v_mfma_f32_16x16x32_bf16 v[44:47], v[20:23], v[8:11], v[44:47]
  v_perm_b32 v28, v198, v194, s51
  s_waitcnt vmcnt(4)
  buffer_load_dwordx4 v[164:167], v2, s[8:11], s64 offen offset:0 nt
  v_perm_b32 v29, v206, v202, s51
  v_perm_b32 v30, v214, v210, s51
  v_perm_b32 v31, v222, v218, s51
  v_mfma_f32_16x16x32_bf16 v[48:51], v[24:27], v[8:11], v[48:51]
  v_perm_b32 v20, v199, v195, s50
  v_perm_b32 v21, v207, v203, s50
  v_perm_b32 v22, v215, v211, s50
  v_perm_b32 v23, v223, v219, s50
  s_waitcnt vmcnt(4)
  buffer_load_dwordx4 v[168:171], v1, s[8:11], s64 offen offset:2048 nt
  v_mfma_f32_16x16x32_bf16 v[52:55], v[28:31], v[8:11], v[52:55]
  v_perm_b32 v24, v199, v195, s51
  v_perm_b32 v25, v207, v203, s51
  v_perm_b32 v26, v215, v211, s51
  v_perm_b32 v27, v223, v219, s51
  v_mfma_f32_16x16x32_bf16 v[56:59], v[20:23], v[8:11], v[56:59]
  v_perm_b32 v28, v228, v224, s50
  v_perm_b32 v29, v236, v232, s50
  s_waitcnt vmcnt(4)
  buffer_load_dwordx4 v[172:175], v2, s[8:11], s64 offen offset:2048 nt
  v_perm_b32 v30, v244, v240, s50
  v_perm_b32 v31, v252, v248, s50
  v_mfma_f32_16x16x32_bf16 v[60:63], v[24:27], v[8:11], v[60:63]
  v_perm_b32 v20, v228, v224, s51
  v_perm_b32 v21, v236, v232, s51
  v_perm_b32 v22, v244, v240, s51
  v_perm_b32 v23, v252, v248, s51
  v_mfma_f32_16x16x32_bf16 v[32:35], v[28:31], v[12:15], v[32:35]
  s_waitcnt vmcnt(4)
  buffer_load_dwordx4 v[176:179], v1, s[8:11], s65 offen offset:0 nt
  v_perm_b32 v24, v229, v225, s50
  v_perm_b32 v25, v237, v233, s50
  v_perm_b32 v26, v245, v241, s50
  v_perm_b32 v27, v253, v249, s50
  v_mfma_f32_16x16x32_bf16 v[36:39], v[20:23], v[12:15], v[36:39]
  v_perm_b32 v28, v229, v225, s51
  v_perm_b32 v29, v237, v233, s51
  s_waitcnt vmcnt(4)
  buffer_load_dwordx4 v[180:183], v2, s[8:11], s65 offen offset:0 nt
  v_perm_b32 v30, v245, v241, s51
  v_perm_b32 v31, v253, v249, s51
  v_mfma_f32_16x16x32_bf16 v[40:43], v[24:27], v[12:15], v[40:43]
  v_perm_b32 v20, v230, v226, s50
  v_perm_b32 v21, v238, v234, s50
  v_perm_b32 v22, v246, v242, s50
  v_perm_b32 v23, v254, v250, s50
  v_mfma_f32_16x16x32_bf16 v[44:47], v[28:31], v[12:15], v[44:47]
  s_waitcnt vmcnt(4)
  buffer_load_dwordx4 v[184:187], v1, s[8:11], s65 offen offset:2048 nt
  v_perm_b32 v24, v230, v226, s51
  v_perm_b32 v25, v238, v234, s51
  v_perm_b32 v26, v246, v242, s51
  v_perm_b32 v27, v254, v250, s51
  v_mfma_f32_16x16x32_bf16 v[48:51], v[20:23], v[12:15], v[48:51]
  v_perm_b32 v28, v231, v227, s50
  v_perm_b32 v29, v239, v235, s50
  v_perm_b32 v30, v247, v243, s50
  s_waitcnt vmcnt(4)
  buffer_load_dwordx4 v[188:191], v2, s[8:11], s65 offen offset:2048 nt
  s_mov_b64 exec, 1
  v_mov_b32 v19, 1
  ds_add_u32 v0, v19 offset:96
  s_mov_b64 exec, -1
  ds_read_b32 v18, v0 offset:4
  v_perm_b32 v31, v255, v251, s50
  v_mfma_f32_16x16x32_bf16 v[52:55], v[24:27], v[12:15], v[52:55]
  v_perm_b32 v20, v231, v227, s51
  v_perm_b32 v21, v239, v235, s51
  v_perm_b32 v22, v247, v243, s51
  v_perm_b32 v23, v255, v251, s51
  v_mfma_f32_16x16x32_bf16 v[56:59], v[28:31], v[12:15], v[56:59]
  s_nop 0
  v_mfma_f32_16x16x32_bf16 v[60:63], v[20:23], v[12:15], v[60:63]
  s_add_u32 s62, s62, 1048576
  s_add_u32 s63, s63, 1048576
  s_add_u32 s64, s64, 1048576
  s_add_u32 s65, s65, 1048576
  s_add_u32 s61, s61, 1
  s_waitcnt lgkmcnt(0)
  v_readfirstlane_b32 s66, v18
  s_lshl_b32 s67, s61, 5
  s_cmp_eq_u32 s66, 0
  s_cselect_b32 s66, s67, s66
  s_sub_i32 s66, s66, s67
  s_cmp_ge_u32 s61, 13
  s_cselect_b32 s67, 64, 0
  s_add_i32 s66, s66, s67
  s_cmp_ge_i32 s66, 8
  s_cbranch_scc1 L_VB0
  s_cmp_ge_i32 s66, -6
  s_cbranch_scc1 L_VN0
L_VS0:
  s_waitcnt vmcnt(4)
  buffer_load_dwordx4 v[192:195], v1, s[8:11], s62 offen offset:0 nt
  ds_read_b64 v[20:21], v4 offset:0
  ds_read_b64 v[22:23], v4 offset:512
  v_add_u32 v4, 1024, v4
  s_waitcnt lgkmcnt(0)
  v_lshlrev_b32 v24, 16, v20
  v_and_b32 v25, 0xffff0000, v20
  v_lshlrev_b32 v26, 16, v21
  s_waitcnt vmcnt(4)
  buffer_load_dwordx4 v[196:199], v2, s[8:11], s62 offen offset:0 nt
  v_and_b32 v27, 0xffff0000, v21
  v_lshlrev_b32 v28, 16, v22
  v_and_b32 v29, 0xffff0000, v22
  v_lshlrev_b32 v30, 16, v23
  v_and_b32 v31, 0xffff0000, v23
  v_fma_f32 v24, v24, s53, -v3
  v_fma_f32 v25, v25, s53, -v3
  v_fma_f32 v26, v26, s53, -v3
  s_waitcnt vmcnt(4)
  buffer_load_dwordx4 v[200:203], v1, s[8:11], s62 offen offset:2048 nt
  v_fma_f32 v27, v27, s53, -v3
  v_fma_f32 v28, v28, s53, -v3
  v_fma_f32 v29, v29, s53, -v3
  v_fma_f32 v30, v30, s53, -v3
  v_fma_f32 v31, v31, s53, -v3
  v_exp_f32 v24, v24
  v_exp_f32 v25, v25
  v_exp_f32 v26, v26
  s_waitcnt vmcnt(4)
  buffer_load_dwordx4 v[204:207], v2, s[8:11], s62 offen offset:2048 nt
  v_exp_f32 v27, v27
  v_exp_f32 v28, v28
  v_exp_f32 v29, v29
  v_exp_f32 v30, v30
  v_exp_f32 v31, v31
  v_cvt_pk_bf16_f32 v8, v24, v25
  v_cvt_pk_bf16_f32 v9, v26, v27
  v_cvt_pk_bf16_f32 v12, v28, v29
  s_waitcnt vmcnt(4)
  buffer_load_dwordx4 v[208:211], v1, s[8:11], s63 offen offset:0 nt
  v_cvt_pk_bf16_f32 v13, v30, v31
  v_add_f32 v24, v24, v25
  v_add_f32 v26, v26, v27
  v_add_f32 v28, v28, v29
  v_add_f32 v30, v30, v31
  v_mov_b32_dpp v10, v8 row_half_mirror row_mask:0xf bank_mask:0xf
  v_mov_b32_dpp v11, v9 row_half_mirror row_mask:0xf bank_mask:0xf
  s_waitcnt vmcnt(4)
  buffer_load_dwordx4 v[212:215], v2, s[8:11], s63 offen offset:0 nt
  v_mov_b32_dpp v14, v12 row_half_mirror row_mask:0xf bank_mask:0xf
  v_mov_b32_dpp v15, v13 row_half_mirror row_mask:0xf bank_mask:0xf
  v_add_f32 v24, v24, v26
  v_add_f32 v28, v28, v30
  v_add_f32 v16, v16, v24
  v_add_f32 v16, v16, v28
  v_perm_b32 v20, v68, v64, s50
  v_perm_b32 v21, v76, v72, s50
  s_waitcnt vmcnt(4)
  buffer_load_dwordx4 v[216:219], v1, s[8:11], s63 offen offset:2048 nt
  v_perm_b32 v22, v84, v80, s50
  v_perm_b32 v23, v92, v88, s50
  v_perm_b32 v24, v68, v64, s51
  v_perm_b32 v25, v76, v72, s51
  v_perm_b32 v26, v84, v80, s51
  v_perm_b32 v27, v92, v88, s51
  v_mfma_f32_16x16x32_bf16 v[32:35], v[20:23], v[8:11], v[32:35]
  v_perm_b32 v28, v69, v65, s50
  s_waitcnt vmcnt(4)
  buffer_load_dwordx4 v[220:223], v2, s[8:11], s63 offen offset:2048 nt
  s_mov_b64 exec, 1
  v_mov_b32 v19, 1
  ds_add_u32 v0, v19 offset:96
  s_mov_b64 exec, -1
  v_perm_b32 v29, v77, v73, s50
  v_perm_b32 v30, v85, v81, s50
  v_perm_b32 v31, v93, v89, s50
  v_mfma_f32_16x16x32_bf16 v[36:39], v[24:27], v[8:11], v[36:39]
  v_perm_b32 v20, v69, v65, s51
  v_perm_b32 v21, v77, v73, s51
  v_perm_b32 v22, v85, v81, s51
  v_perm_b32 v23, v93, v89, s51
  s_waitcnt vmcnt(4)
  buffer_load_dwordx4 v[224:227], v1, s[8:11], s64 offen offset:0 nt
  v_mfma_f32_16x16x32_bf16 v[40:43], v[28:31], v[8:11], v[40:43]
  v_perm_b32 v24, v70, v66, s50
  v_perm_b32 v25, v78, v74, s50
  v_perm_b32 v26, v86, v82, s50
  v_perm_b32 v27, v94, v90, s50
  v_mfma_f32_16x16x32_bf16 v[44:47], v[20:23], v[8:11], v[44:47]
  v_perm_b32 v28, v70, v66, s51
  s_waitcnt vmcnt(4)
  buffer_load_dwordx4 v[228:231], v2, s[8:11], s64 offen offset:0 nt
  v_perm_b32 v29, v78, v74, s51
  v_perm_b32 v30, v86, v82, s51
  v_perm_b32 v31, v94, v90, s51
  v_mfma_f32_16x16x32_bf16 v[48:51], v[24:27], v[8:11], v[48:51]
  v_perm_b32 v20, v71, v67, s50
  v_perm_b32 v21, v79, v75, s50
  v_perm_b32 v22, v87, v83, s50
  v_perm_b32 v23, v95, v91, s50
  s_waitcnt vmcnt(4)
  buffer_load_dwordx4 v[232:235], v1, s[8:11], s64 offen offset:2048 nt
  v_mfma_f32_16x16x32_bf16 v[52:55], v[28:31], v[8:11], v[52:55]
  v_perm_b32 v24, v71, v67, s51
  v_perm_b32 v25, v79, v75, s51
  v_perm_b32 v26, v87, v83, s51
  v_perm_b32 v27, v95, v91, s51
  v_mfma_f32_16x16x32_bf16 v[56:59], v[20:23], v[8:11], v[56:59]
  v_perm_b32 v28, v100, v96, s50
  v_perm_b32 v29, v108, v104, s50
  s_waitcnt vmcnt(4)
  buffer_load_dwordx4 v[236:239], v2, s[8:11], s64 offen offset:2048 nt
  v_perm_b32 v30, v116, v112, s50
  v_perm_b32 v31, v124, v120, s50
  v_mfma_f32_16x16x32_bf16 v[60:63], v[24:27], v[8:11], v[60:63]
  v_perm_b32 v20, v100, v96, s51
  v_perm_b32 v21, v108, v104, s51
  v_perm_b32 v22, v116, v112, s51
  v_perm_b32 v23, v124, v120, s51
  v_mfma_f32_16x16x32_bf16 v[32:35], v[28:31], v[12:15], v[32:35]
  s_waitcnt vmcnt(4)
  buffer_load_dwordx4 v[240:243], v1, s[8:11], s65 offen offset:0 nt
  v_perm_b32 v24, v101, v97, s50
  v_perm_b32 v25, v109, v105, s50
  v_perm_b32 v26, v117, v113, s50
  v_perm_b32 v27, v125, v121, s50
  v_mfma_f32_16x16x32_bf16 v[36:39], v[20:23], v[12:15], v[36:39]
  v_perm_b32 v28, v101, v97, s51
  v_perm_b32 v29, v109, v105, s51
  s_waitcnt vmcnt(4)
  buffer_load_dwordx4 v[244:247], v2, s[8:11], s65 offen offset:0 nt
  v_perm_b32 v30, v117, v113, s51
  v_perm_b32 v31, v125, v121, s51
  v_mfma_f32_16x16x32_bf16 v[40:43], v[24:27], v[12:15], v[40:43]
  v_perm_b32 v20, v102, v98, s50
  v_perm_b32 v21, v110, v106, s50
  v_perm_b32 v22, v118, v114, s50
  v_perm_b32 v23, v126, v122, s50
  v_mfma_f32_16x16x32_bf16 v[44:47], v[28:31], v[12:15], v[44:47]
  s_waitcnt vmcnt(4)
  buffer_load_dwordx4 v[248:251], v1, s[8:11], s65 offen offset:2048 nt
  v_perm_b32 v24, v102, v98, s51
  v_perm_b32 v25, v110, v106, s51
  v_perm_b32 v26, v118, v114, s51
  v_perm_b32 v27, v126, v122, s51
  v_mfma_f32_16x16x32_bf16 v[48:51], v[20:23], v[12:15], v[48:51]
  v_perm_b32 v28, v103, v99, s50
  v_perm_b32 v29, v111, v107, s50
  v_perm_b32 v30, v119, v115, s50
  s_waitcnt vmcnt(4)
  buffer_load_dwordx4 v[252:255], v2, s[8:11], s65 offen offset:2048 nt
  s_mov_b64 exec, 1
  v_mov_b32 v19, 1
  ds_add_u32 v0, v19 offset:96
  s_mov_b64 exec, -1
  ds_read_b32 v18, v0 offset:4
  v_perm_b32 v31, v127, v123, s50
  v_mfma_f32_16x16x32_bf16 v[52:55], v[24:27], v[12:15], v[52:55]
  v_perm_b32 v20, v103, v99, s51
  v_perm_b32 v21, v111, v107, s51
  v_perm_b32 v22, v119, v115, s51
  v_perm_b32 v23, v127, v123, s51
  v_mfma_f32_16x16x32_bf16 v[56:59], v[28:31], v[12:15], v[56:59]
  s_nop 0
  v_mfma_f32_16x16x32_bf16 v[60:63], v[20:23], v[12:15], v[60:63]
  s_add_u32 s62, s62, 1048576
  s_add_u32 s63, s63, 1048576
  s_add_u32 s64, s64, 1048576
  s_add_u32 s65, s65, 1048576
  s_add_u32 s61, s61, 1
  s_waitcnt lgkmcnt(0)
  v_readfirstlane_b32 s66, v18
  s_lshl_b32 s67, s61, 5
  s_cmp_eq_u32 s66, 0
  s_cselect_b32 s66, s67, s66
  s_sub_i32 s66, s66, s67
  s_cmp_ge_u32 s61, 13
  s_cselect_b32 s67, 64, 0
  s_add_i32 s66, s66, s67
  s_cmp_ge_i32 s66, 8
  s_cbranch_scc1 L_VB1
  s_cmp_ge_i32 s66, -6
  s_cbranch_scc1 L_VN1
L_VS1:
  s_waitcnt vmcnt(4)
  buffer_load_dwordx4 v[64:67], v1, s[8:11], s62 offen offset:0 nt
  ds_read_b64 v[20:21], v4 offset:0
  ds_read_b64 v[22:23], v4 offset:512
  v_add_u32 v4, 1024, v4
  s_waitcnt lgkmcnt(0)
  v_lshlrev_b32 v24, 16, v20
  v_and_b32 v25, 0xffff0000, v20
  v_lshlrev_b32 v26, 16, v21
  s_waitcnt vmcnt(4)
  buffer_load_dwordx4 v[68:71], v2, s[8:11], s62 offen offset:0 nt
  v_and_b32 v27, 0xffff0000, v21
  v_lshlrev_b32 v28, 16, v22
  v_and_b32 v29, 0xffff0000, v22
  v_lshlrev_b32 v30, 16, v23
  v_and_b32 v31, 0xffff0000, v23
  v_fma_f32 v24, v24, s53, -v3
  v_fma_f32 v25, v25, s53, -v3
  v_fma_f32 v26, v26, s53, -v3
  s_waitcnt vmcnt(4)
  buffer_load_dwordx4 v[72:75], v1, s[8:11], s62 offen offset:2048 nt
  v_fma_f32 v27, v27, s53, -v3
  v_fma_f32 v28, v28, s53, -v3
  v_fma_f32 v29, v29, s53, -v3
  v_fma_f32 v30, v30, s53, -v3
  v_fma_f32 v31, v31, s53, -v3
  v_exp_f32 v24, v24
  v_exp_f32 v25, v25
  v_exp_f32 v26, v26
  s_waitcnt vmcnt(4)
  buffer_load_dwordx4 v[76:79], v2, s[8:11], s62 offen offset:2048 nt
  v_exp_f32 v27, v27
  v_exp_f32 v28, v28
  v_exp_f32 v29, v29
  v_exp_f32 v30, v30
  v_exp_f32 v31, v31
  v_cvt_pk_bf16_f32 v8, v24, v25
  v_cvt_pk_bf16_f32 v9, v26, v27
  v_cvt_pk_bf16_f32 v12, v28, v29
  s_waitcnt vmcnt(4)
  buffer_load_dwordx4 v[80:83], v1, s[8:11], s63 offen offset:0 nt
  v_cvt_pk_bf16_f32 v13, v30, v31
  v_add_f32 v24, v24, v25
  v_add_f32 v26, v26, v27
  v_add_f32 v28, v28, v29
  v_add_f32 v30, v30, v31
  v_mov_b32_dpp v10, v8 row_half_mirror row_mask:0xf bank_mask:0xf
  v_mov_b32_dpp v11, v9 row_half_mirror row_mask:0xf bank_mask:0xf
  s_waitcnt vmcnt(4)
  buffer_load_dwordx4 v[84:87], v2, s[8:11], s63 offen offset:0 nt
  v_mov_b32_dpp v14, v12 row_half_mirror row_mask:0xf bank_mask:0xf
  v_mov_b32_dpp v15, v13 row_half_mirror row_mask:0xf bank_mask:0xf
  v_add_f32 v24, v24, v26
  v_add_f32 v28, v28, v30
  v_add_f32 v16, v16, v24
  v_add_f32 v16, v16, v28
  v_perm_b32 v20, v132, v128, s50
  v_perm_b32 v21, v140, v136, s50
  s_waitcnt vmcnt(4)
  buffer_load_dwordx4 v[88:91], v1, s[8:11], s63 offen offset:2048 nt
  v_perm_b32 v22, v148, v144, s50
  v_perm_b32 v23, v156, v152, s50
  v_perm_b32 v24, v132, v128, s51
  v_perm_b32 v25, v140, v136, s51
  v_perm_b32 v26, v148, v144, s51
  v_perm_b32 v27, v156, v152, s51
  v_mfma_f32_16x16x32_bf16 v[32:35], v[20:23], v[8:11], v[32:35]
  v_perm_b32 v28, v133, v129, s50
  s_waitcnt vmcnt(4)
  buffer_load_dwordx4 v[92:95], v2, s[8:11], s63 offen offset:2048 nt
  s_mov_b64 exec, 1
  v_mov_b32 v19, 1
  ds_add_u32 v0, v19 offset:96
  s_mov_b64 exec, -1
  v_perm_b32 v29, v141, v137, s50
  v_perm_b32 v30, v149, v145, s50
  v_perm_b32 v31, v157, v153, s50
  v_mfma_f32_16x16x32_bf16 v[36:39], v[24:27], v[8:11], v[36:39]
  v_perm_b32 v20, v133, v129, s51
  v_perm_b32 v21, v141, v137, s51
  v_perm_b32 v22, v149, v145, s51
  v_perm_b32 v23, v157, v153, s51
  s_waitcnt vmcnt(4)
  buffer_load_dwordx4 v[96:99], v1, s[8:11], s64 offen offset:0 nt
  v_mfma_f32_16x16x32_bf16 v[40:43], v[28:31], v[8:11], v[40:43]
  v_perm_b32 v24, v134, v130, s50
  v_perm_b32 v25, v142, v138, s50
  v_perm_b32 v26, v150, v146, s50
  v_perm_b32 v27, v158, v154, s50
  v_mfma_f32_16x16x32_bf16 v[44:47], v[20:23], v[8:11], v[44:47]
  v_perm_b32 v28, v134, v130, s51
  s_waitcnt vmcnt(4)
  buffer_load_dwordx4 v[100:103], v2, s[8:11], s64 offen offset:0 nt
  v_perm_b32 v29, v142, v138, s51
  v_perm_b32 v30, v150, v146, s51
  v_perm_b32 v31, v158, v154, s51
  v_mfma_f32_16x16x32_bf16 v[48:51], v[24:27], v[8:11], v[48:51]
  v_perm_b32 v20, v135, v131, s50
  v_perm_b32 v21, v143, v139, s50
  v_perm_b32 v22, v151, v147, s50
  v_perm_b32 v23, v159, v155, s50
  s_waitcnt vmcnt(4)
  buffer_load_dwordx4 v[104:107], v1, s[8:11], s64 offen offset:2048 nt
  v_mfma_f32_16x16x32_bf16 v[52:55], v[28:31], v[8:11], v[52:55]
  v_perm_b32 v24, v135, v131, s51
  v_perm_b32 v25, v143, v139, s51
  v_perm_b32 v26, v151, v147, s51
  v_perm_b32 v27, v159, v155, s51
  v_mfma_f32_16x16x32_bf16 v[56:59], v[20:23], v[8:11], v[56:59]
  v_perm_b32 v28, v164, v160, s50
  v_perm_b32 v29, v172, v168, s50
  s_waitcnt vmcnt(4)
  buffer_load_dwordx4 v[108:111], v2, s[8:11], s64 offen offset:2048 nt
  v_perm_b32 v30, v180, v176, s50
  v_perm_b32 v31, v188, v184, s50
  v_mfma_f32_16x16x32_bf16 v[60:63], v[24:27], v[8:11], v[60:63]
  v_perm_b32 v20, v164, v160, s51
  v_perm_b32 v21, v172, v168, s51
  v_perm_b32 v22, v180, v176, s51
  v_perm_b32 v23, v188, v184, s51
  v_mfma_f32_16x16x32_bf16 v[32:35], v[28:31], v[12:15], v[32:35]
  s_waitcnt vmcnt(4)
  buffer_load_dwordx4 v[112:115], v1, s[8:11], s65 offen offset:0 nt
  v_perm_b32 v24, v165, v161, s50
  v_perm_b32 v25, v173, v169, s50
  v_perm_b32 v26, v181, v177, s50
  v_perm_b32 v27, v189, v185, s50
  v_mfma_f32_16x16x32_bf16 v[36:39], v[20:23], v[12:15], v[36:39]
  v_perm_b32 v28, v165, v161, s51
  v_perm_b32 v29, v173, v169, s51
  s_waitcnt vmcnt(4)
  buffer_load_dwordx4 v[116:119], v2, s[8:11], s65 offen offset:0 nt
  v_perm_b32 v30, v181, v177, s51
  v_perm_b32 v31, v189, v185, s51
  v_mfma_f32_16x16x32_bf16 v[40:43], v[24:27], v[12:15], v[40:43]
  v_perm_b32 v20, v166, v162, s50
  v_perm_b32 v21, v174, v170, s50
  v_perm_b32 v22, v182, v178, s50
  v_perm_b32 v23, v190, v186, s50
  v_mfma_f32_16x16x32_bf16 v[44:47], v[28:31], v[12:15], v[44:47]
  s_waitcnt vmcnt(4)
  buffer_load_dwordx4 v[120:123], v1, s[8:11], s65 offen offset:2048 nt
  v_perm_b32 v24, v166, v162, s51
  v_perm_b32 v25, v174, v170, s51
  v_perm_b32 v26, v182, v178, s51
  v_perm_b32 v27, v190, v186, s51
  v_mfma_f32_16x16x32_bf16 v[48:51], v[20:23], v[12:15], v[48:51]
  v_perm_b32 v28, v167, v163, s50
  v_perm_b32 v29, v175, v171, s50
  v_perm_b32 v30, v183, v179, s50
  s_waitcnt vmcnt(4)
  buffer_load_dwordx4 v[124:127], v2, s[8:11], s65 offen offset:2048 nt
  s_mov_b64 exec, 1
  v_mov_b32 v19, 1
  ds_add_u32 v0, v19 offset:96
  s_mov_b64 exec, -1
  ds_read_b32 v18, v0 offset:4
  v_perm_b32 v31, v191, v187, s50
  v_mfma_f32_16x16x32_bf16 v[52:55], v[24:27], v[12:15], v[52:55]
  v_perm_b32 v20, v167, v163, s51
  v_perm_b32 v21, v175, v171, s51
  v_perm_b32 v22, v183, v179, s51
  v_perm_b32 v23, v191, v187, s51
  v_mfma_f32_16x16x32_bf16 v[56:59], v[28:31], v[12:15], v[56:59]
  s_nop 0
  v_mfma_f32_16x16x32_bf16 v[60:63], v[20:23], v[12:15], v[60:63]
  s_add_u32 s62, s62, 1048576
  s_add_u32 s63, s63, 1048576
  s_add_u32 s64, s64, 1048576
  s_add_u32 s65, s65, 1048576
  s_add_u32 s61, s61, 1
  s_waitcnt lgkmcnt(0)
  v_readfirstlane_b32 s66, v18
  s_cmp_eq_u32 s61, 14
  s_cbranch_scc1 L_n2
  s_lshl_b32 s67, s61, 5
  s_cmp_eq_u32 s66, 0
  s_cselect_b32 s66, s67, s66
  s_sub_i32 s66, s66, s67
  s_cmp_ge_u32 s61, 13
  s_cselect_b32 s67, 64, 0
  s_add_i32 s66, s66, s67
  s_cmp_ge_i32 s66, 8
  s_cbranch_scc1 L_VB2
  s_cmp_ge_i32 s66, -6
  s_cbranch_scc1 L_VN2
  s_branch L_VS2
L_n2:
  s_mov_b64 exec, 1
  v_mov_b32 v7, 1
  ds_add_u32 v0, v7
  s_mov_b64 exec, -1
  ds_read_b64 v[20:21], v4 offset:0
  ds_read_b64 v[22:23], v4 offset:512
  v_add_u32 v4, 1024, v4
  s_waitcnt lgkmcnt(0)
  v_lshlrev_b32 v24, 16, v20
  v_and_b32 v25, 0xffff0000, v20
  v_lshlrev_b32 v26, 16, v21
  v_and_b32 v27, 0xffff0000, v21
  v_lshlrev_b32 v28, 16, v22
  v_and_b32 v29, 0xffff0000, v22
  v_lshlrev_b32 v30, 16, v23
  v_and_b32 v31, 0xffff0000, v23
  v_fma_f32 v24, v24, s53, -v3
  v_fma_f32 v25, v25, s53, -v3
  v_fma_f32 v26, v26, s53, -v3
  v_fma_f32 v27, v27, s53, -v3
  v_fma_f32 v28, v28, s53, -v3
  v_fma_f32 v29, v29, s53, -v3
  v_fma_f32 v30, v30, s53, -v3
  v_fma_f32 v31, v31, s53, -v3
  v_exp_f32 v24, v24
  v_exp_f32 v25, v25
  v_exp_f32 v26, v26
  v_exp_f32 v27, v27
  v_exp_f32 v28, v28
  v_exp_f32 v29, v29
  v_exp_f32 v30, v30
  v_exp_f32 v31, v31
  v_cvt_pk_bf16_f32 v8, v24, v25
  v_cvt_pk_bf16_f32 v9, v26, v27
  v_cvt_pk_bf16_f32 v12, v28, v29
  v_cvt_pk_bf16_f32 v13, v30, v31
  v_add_f32 v24, v24, v25
  v_add_f32 v26, v26, v27
  v_add_f32 v28, v28, v29
  v_add_f32 v30, v30, v31
  v_mov_b32_dpp v10, v8 row_half_mirror row_mask:0xf bank_mask:0xf
  v_mov_b32_dpp v11, v9 row_half_mirror row_mask:0xf bank_mask:0xf
  v_mov_b32_dpp v14, v12 row_half_mirror row_mask:0xf bank_mask:0xf
  v_mov_b32_dpp v15, v13 row_half_mirror row_mask:0xf bank_mask:0xf
  v_add_f32 v24, v24, v26
  v_add_f32 v28, v28, v30
  v_add_f32 v16, v16, v24
  v_add_f32 v16, v16, v28
  s_waitcnt vmcnt(16)
  v_perm_b32 v20, v196, v192, s50
  v_perm_b32 v21, v204, v200, s50
  v_perm_b32 v22, v212, v208, s50
  v_perm_b32 v23, v220, v216, s50
  v_perm_b32 v24, v196, v192, s51
  v_perm_b32 v25, v204, v200, s51
  v_perm_b32 v26, v212, v208, s51
  v_perm_b32 v27, v220, v216, s51
  v_mfma_f32_16x16x32_bf16 v[32:35], v[20:23], v[8:11], v[32:35]
  v_perm_b32 v28, v197, v193, s50
  v_perm_b32 v29, v205, v201, s50
  v_perm_b32 v30, v213, v209, s50
  v_perm_b32 v31, v221, v217, s50
  v_mfma_f32_16x16x32_bf16 v[36:39], v[24:27], v[8:11], v[36:39]
  v_perm_b32 v20, v197, v193, s51
  v_perm_b32 v21, v205, v201, s51
  v_perm_b32 v22, v213, v209, s51
  v_perm_b32 v23, v221, v217, s51
  v_mfma_f32_16x16x32_bf16 v[40:43], v[28:31], v[8:11], v[40:43]
  v_perm_b32 v24, v198, v194, s50
  v_perm_b32 v25, v206, v202, s50
  v_perm_b32 v26, v214, v210, s50
  v_perm_b32 v27, v222, v218, s50
  v_mfma_f32_16x16x32_bf16 v[44:47], v[20:23], v[8:11], v[44:47]
  v_perm_b32 v28, v198, v194, s51
  v_perm_b32 v29, v206, v202, s51
  v_perm_b32 v30, v214, v210, s51
  v_perm_b32 v31, v222, v218, s51
  v_mfma_f32_16x16x32_bf16 v[48:51], v[24:27], v[8:11], v[48:51]
  v_perm_b32 v20, v199, v195, s50
  v_perm_b32 v21, v207, v203, s50
  v_perm_b32 v22, v215, v211, s50
  v_perm_b32 v23, v223, v219, s50
  v_mfma_f32_16x16x32_bf16 v[52:55], v[28:31], v[8:11], v[52:55]
  v_perm_b32 v24, v199, v195, s51
  v_perm_b32 v25, v207, v203, s51
  v_perm_b32 v26, v215, v211, s51
  v_perm_b32 v27, v223, v219, s51
  v_mfma_f32_16x16x32_bf16 v[56:59], v[20:23], v[8:11], v[56:59]
  v_perm_b32 v28, v228, v224, s50
  v_perm_b32 v29, v236, v232, s50
  v_perm_b32 v30, v244, v240, s50
  v_perm_b32 v31, v252, v248, s50
  v_mfma_f32_16x16x32_bf16 v[60:63], v[24:27], v[8:11], v[60:63]
  v_perm_b32 v20, v228, v224, s51
  v_perm_b32 v21, v236, v232, s51
  v_perm_b32 v22, v244, v240, s51
  v_perm_b32 v23, v252, v248, s51
  v_mfma_f32_16x16x32_bf16 v[32:35], v[28:31], v[12:15], v[32:35]
  v_perm_b32 v24, v229, v225, s50
  v_perm_b32 v25, v237, v233, s50
  v_perm_b32 v26, v245, v241, s50
  v_perm_b32 v27, v253, v249, s50
  v_mfma_f32_16x16x32_bf16 v[36:39], v[20:23], v[12:15], v[36:39]
  v_perm_b32 v28, v229, v225, s51
  v_perm_b32 v29, v237, v233, s51
  v_perm_b32 v30, v245, v241, s51
  v_perm_b32 v31, v253, v249, s51
  v_mfma_f32_16x16x32_bf16 v[40:43], v[24:27], v[12:15], v[40:43]
  v_perm_b32 v20, v230, v226, s50
  v_perm_b32 v21, v238, v234, s50
  v_perm_b32 v22, v246, v242, s50
  v_perm_b32 v23, v254, v250, s50
  v_mfma_f32_16x16x32_bf16 v[44:47], v[28:31], v[12:15], v[44:47]
  v_perm_b32 v24, v230, v226, s51
  v_perm_b32 v25, v238, v234, s51
  v_perm_b32 v26, v246, v242, s51
  v_perm_b32 v27, v254, v250, s51
  v_mfma_f32_16x16x32_bf16 v[48:51], v[20:23], v[12:15], v[48:51]
  v_perm_b32 v28, v231, v227, s50
  v_perm_b32 v29, v239, v235, s50
  v_perm_b32 v30, v247, v243, s50
  v_perm_b32 v31, v255, v251, s50
  v_mfma_f32_16x16x32_bf16 v[52:55], v[24:27], v[12:15], v[52:55]
  v_perm_b32 v20, v231, v227, s51
  v_perm_b32 v21, v239, v235, s51
  v_perm_b32 v22, v247, v243, s51
  v_perm_b32 v23, v255, v251, s51
  v_mfma_f32_16x16x32_bf16 v[56:59], v[28:31], v[12:15], v[56:59]
  s_nop 0
  v_mfma_f32_16x16x32_bf16 v[60:63], v[20:23], v[12:15], v[60:63]
  ds_read_b64 v[20:21], v4 offset:0
  ds_read_b64 v[22:23], v4 offset:512
  v_add_u32 v4, 1024, v4
  s_waitcnt lgkmcnt(0)
  v_lshlrev_b32 v24, 16, v20
  v_and_b32 v25, 0xffff0000, v20
  v_lshlrev_b32 v26, 16, v21
  v_and_b32 v27, 0xffff0000, v21
  v_lshlrev_b32 v28, 16, v22
  v_and_b32 v29, 0xffff0000, v22
  v_lshlrev_b32 v30, 16, v23
  v_and_b32 v31, 0xffff0000, v23
  v_fma_f32 v24, v24, s53, -v3
  v_fma_f32 v25, v25, s53, -v3
  v_fma_f32 v26, v26, s53, -v3
  v_fma_f32 v27, v27, s53, -v3
  v_fma_f32 v28, v28, s53, -v3
  v_fma_f32 v29, v29, s53, -v3
  v_fma_f32 v30, v30, s53, -v3
  v_fma_f32 v31, v31, s53, -v3
  v_exp_f32 v24, v24
  v_exp_f32 v25, v25
  v_exp_f32 v26, v26
  v_exp_f32 v27, v27
  v_exp_f32 v28, v28
  v_exp_f32 v29, v29
  v_exp_f32 v30, v30
  v_exp_f32 v31, v31
  v_cvt_pk_bf16_f32 v8, v24, v25
  v_cvt_pk_bf16_f32 v9, v26, v27
  v_cvt_pk_bf16_f32 v12, v28, v29
  v_cvt_pk_bf16_f32 v13, v30, v31
  v_add_f32 v24, v24, v25
  v_add_f32 v26, v26, v27
  v_add_f32 v28, v28, v29
  v_add_f32 v30, v30, v31
  v_mov_b32_dpp v10, v8 row_half_mirror row_mask:0xf bank_mask:0xf
  v_mov_b32_dpp v11, v9 row_half_mirror row_mask:0xf bank_mask:0xf
  v_mov_b32_dpp v14, v12 row_half_mirror row_mask:0xf bank_mask:0xf
  v_mov_b32_dpp v15, v13 row_half_mirror row_mask:0xf bank_mask:0xf
  v_add_f32 v24, v24, v26
  v_add_f32 v28, v28, v30
  v_add_f32 v16, v16, v24
  v_add_f32 v16, v16, v28
  s_nop 1
  v_add_f32_dpp v16, v16, v16 row_half_mirror row_mask:0xf bank_mask:0xf
  v_mov_b32 v7, v16
  s_nop 1
  v_permlane16_swap_b32 v16, v7
  v_add_f32 v16, v16, v7
  v_mov_b32 v7, v16
  s_nop 1
  v_permlane32_swap_b32 v16, v7
  v_add_f32 v16, v16, v7
  s_mov_b64 exec, s[56:57]
  ds_write2_b32 v6, v3, v16 offset0:0 offset1:16
  s_mov_b64 exec, -1
  s_waitcnt vmcnt(8)
  v_perm_b32 v20, v68, v64, s50
  v_perm_b32 v21, v76, v72, s50
  v_perm_b32 v22, v84, v80, s50
  v_perm_b32 v23, v92, v88, s50
  v_perm_b32 v24, v68, v64, s51
  v_perm_b32 v25, v76, v72, s51
  v_perm_b32 v26, v84, v80, s51
  v_perm_b32 v27, v92, v88, s51
  v_mfma_f32_16x16x32_bf16 v[32:35], v[20:23], v[8:11], v[32:35]
  v_perm_b32 v28, v69, v65, s50
  v_perm_b32 v29, v77, v73, s50
  v_perm_b32 v30, v85, v81, s50
  v_perm_b32 v31, v93, v89, s50
  v_mfma_f32_16x16x32_bf16 v[36:39], v[24:27], v[8:11], v[36:39]
  v_perm_b32 v20, v69, v65, s51
  v_perm_b32 v21, v77, v73, s51
  v_perm_b32 v22, v85, v81, s51
  v_perm_b32 v23, v93, v89, s51
  v_mfma_f32_16x16x32_bf16 v[40:43], v[28:31], v[8:11], v[40:43]
  v_perm_b32 v24, v70, v66, s50
  v_perm_b32 v25, v78, v74, s50
  v_perm_b32 v26, v86, v82, s50
  v_perm_b32 v27, v94, v90, s50
  v_mfma_f32_16x16x32_bf16 v[44:47], v[20:23], v[8:11], v[44:47]
  v_perm_b32 v28, v70, v66, s51
  v_perm_b32 v29, v78, v74, s51
  v_perm_b32 v30, v86, v82, s51
  v_perm_b32 v31, v94, v90, s51
  v_mfma_f32_16x16x32_bf16 v[48:51], v[24:27], v[8:11], v[48:51]
  v_perm_b32 v20, v71, v67, s50
  v_perm_b32 v21, v79, v75, s50
  v_perm_b32 v22, v87, v83, s50
  v_perm_b32 v23, v95, v91, s50
  v_mfma_f32_16x16x32_bf16 v[52:55], v[28:31], v[8:11], v[52:55]
  v_perm_b32 v24, v71, v67, s51
  v_perm_b32 v25, v79, v75, s51
  v_perm_b32 v26, v87, v83, s51
  v_perm_b32 v27, v95, v91, s51
  v_mfma_f32_16x16x32_bf16 v[56:59], v[20:23], v[8:11], v[56:59]
  s_nop 0
  v_mfma_f32_16x16x32_bf16 v[60:63], v[24:27], v[8:11], v[60:63]
  s_waitcnt vmcnt(0)
  v_perm_b32 v28, v100, v96, s50
  v_perm_b32 v29, v108, v104, s50
  v_perm_b32 v30, v116, v112, s50
  v_perm_b32 v31, v124, v120, s50
  v_perm_b32 v20, v100, v96, s51
  v_perm_b32 v21, v108, v104, s51
  v_perm_b32 v22, v116, v112, s51
  v_perm_b32 v23, v124, v120, s51
  v_mfma_f32_16x16x32_bf16 v[32:35], v[28:31], v[12:15], v[32:35]
  v_perm_b32 v24, v101, v97, s50
  v_perm_b32 v25, v109, v105, s50
  v_perm_b32 v26, v117, v113, s50
  v_perm_b32 v27, v125, v121, s50
  v_mfma_f32_16x16x32_bf16 v[36:39], v[20:23], v[12:15], v[36:39]
  v_perm_b32 v28, v101, v97, s51
  v_perm_b32 v29, v109, v105, s51
  v_perm_b32 v30, v117, v113, s51
  v_perm_b32 v31, v125, v121, s51
  v_mfma_f32_16x16x32_bf16 v[40:43], v[24:27], v[12:15], v[40:43]
  v_perm_b32 v20, v102, v98, s50
  v_perm_b32 v21, v110, v106, s50
  v_perm_b32 v22, v118, v114, s50
  v_perm_b32 v23, v126, v122, s50
  v_mfma_f32_16x16x32_bf16 v[44:47], v[28:31], v[12:15], v[44:47]
  v_perm_b32 v24, v102, v98, s51
  v_perm_b32 v25, v110, v106, s51
  v_perm_b32 v26, v118, v114, s51
  v_perm_b32 v27, v126, v122, s51
  v_mfma_f32_16x16x32_bf16 v[48:51], v[20:23], v[12:15], v[48:51]
  v_perm_b32 v28, v103, v99, s50
  v_perm_b32 v29, v111, v107, s50
  v_perm_b32 v30, v119, v115, s50
  v_perm_b32 v31, v127, v123, s50
  v_mfma_f32_16x16x32_bf16 v[52:55], v[24:27], v[12:15], v[52:55]
  v_perm_b32 v20, v103, v99, s51
  v_perm_b32 v21, v111, v107, s51
  v_perm_b32 v22, v119, v115, s51
  v_perm_b32 v23, v127, v123, s51
  v_mfma_f32_16x16x32_bf16 v[56:59], v[28:31], v[12:15], v[56:59]
  s_nop 0
  v_mfma_f32_16x16x32_bf16 v[60:63], v[20:23], v[12:15], v[60:63]
L_sdone:
  s_mov_b64 exec, s[56:57]
  ds_write_b128 v5, v[32:35] offset:0
  ds_write_b128 v5, v[36:39] offset:16
  ds_write_b128 v5, v[40:43] offset:32
  ds_write_b128 v5, v[44:47] offset:48
  ds_write_b128 v5, v[48:51] offset:64
  ds_write_b128 v5, v[52:55] offset:80
  ds_write_b128 v5, v[56:59] offset:96
  ds_write_b128 v5, v[60:63] offset:112
  s_waitcnt lgkmcnt(0)
  s_barrier
  s_branch L_fin
L_helper:
  s_setprio 3
  v_lshlrev_b32 v6, 2, v0
  v_mov_b32 v5, 0
  ds_write_b32 v6, v5 offset:6144
  s_sub_u32 s54, s3, 4
  s_lshl_b32 s47, s6, 4
  s_add_u32 s47, s47, s5
  s_lshl_b32 s46, s7, 4
  s_add_u32 s46, s46, s5
  s_mul_i32 s55, s7, 14
  s_add_u32 s55, s55, s5
  s_add_u32 s55, s55, 128
  s_cmp_lt_u32 s5, 14
  s_cselect_b32 s55, s55, 255
  s_cmp_eq_u32 s6, 0
  s_cselect_b32 s46, s46, s55
  v_lshrrev_b32 v1, 4, v0
  v_and_b32 v2, 15, v0
  v_lshlrev_b32 v3, 4, v0
  s_and_b32 s55, s46, 3
  s_lshl_b32 s55, s55, 7
  s_lshl_b32 s56, s54, 5
  s_add_u32 s55, s55, s56
  s_sub_u32 s57, s46, 128
  s_lshr_b32 s58, s57, 3
  s_lshr_b32 s59, s46, 2
  s_cmp_lt_u32 s46, 128
  s_cselect_b32 s58, s59, s58
  s_movk_i32 s59, 3584
  s_cselect_b32 s59, 8192, s59
  s_lshl_b32 s42, s59, 9
  s_mov_b32 s43, 0x20000
  v_and_b32 v4, 1, v0
  v_lshlrev_b32 v4, 10, v4
  v_lshl_add_u32 v4, v1, 4, v4
  s_lshl_b32 s56, s55, 1
  v_add_u32 v4, s56, v4
  v_lshlrev_b32 v5, 3, v1
  v_mul_lo_u32 v5, v5, s59
  v_lshl_add_u32 v5, v2, 4, v5
  s_mul_i32 s56, s55, s59
  s_lshl_b32 s58, s58, 8
  s_add_u32 s56, s56, s58
  s_waitcnt lgkmcnt(0)
  s_barrier
  s_load_dword s48, s[38:39], 258048
  s_bitcmp1_b32 s57, 2
  s_cselect_b32 s40, s30, s28
  s_cselect_b32 s41, s31, s29
  s_cmp_lt_u32 s46, 128
  s_cselect_b32 s40, s22, s40
  s_cselect_b32 s41, s23, s41
  s_and_b32 s41, s41, 0xffff
  s_cmp_ge_u32 s46, 240
  s_cbranch_scc1 L_nopre0
  global_load_dwordx4 v[8:11], v3, s[16:17]
  buffer_load_dwordx4 v[64:67], v5, s[40:43], s56 offen nt
  global_load_dwordx4 v[12:15], v3, s[16:17] offset:1024
  global_load_dwordx4 v[16:19], v4, s[16:17]
  s_add_u32 s56, s56, s59
  buffer_load_dwordx4 v[68:71], v5, s[40:43], s56 offen nt
  s_add_u32 s56, s56, s59
  buffer_load_dwordx4 v[72:75], v5, s[40:43], s56 offen nt
  s_add_u32 s56, s56, s59
  buffer_load_dwordx4 v[76:79], v5, s[40:43], s56 offen nt
  s_add_u32 s56, s56, s59
  buffer_load_dwordx4 v[80:83], v5, s[40:43], s56 offen nt
  s_add_u32 s56, s56, s59
  buffer_load_dwordx4 v[84:87], v5, s[40:43], s56 offen nt
  s_add_u32 s56, s56, s59
  buffer_load_dwordx4 v[88:91], v5, s[40:43], s56 offen nt
  s_add_u32 s56, s56, s59
  buffer_load_dwordx4 v[92:95], v5, s[40:43], s56 offen nt
L_nopre0:
  s_mov_b32 s50, 0x05040100
  s_mov_b32 s51, 0x07060302
  s_movk_i32 s49, 0xff
  s_mov_b32 s71, 0
  s_cmp_ge_u32 s46, 240
  s_cbranch_scc1 L_nopre
  s_waitcnt vmcnt(7)
  v_lshlrev_b32 v144, 16, v8
  v_and_b32 v145, 0xffff0000, v8
  v_lshlrev_b32 v146, 16, v9
  v_and_b32 v147, 0xffff0000, v9
  v_lshlrev_b32 v148, 16, v10
  v_and_b32 v149, 0xffff0000, v10
  v_lshlrev_b32 v150, 16, v11
  v_and_b32 v151, 0xffff0000, v11
  v_lshlrev_b32 v152, 16, v12
  v_and_b32 v153, 0xffff0000, v12
  v_lshlrev_b32 v154, 16, v13
  v_and_b32 v155, 0xffff0000, v13
  v_lshlrev_b32 v156, 16, v14
  v_and_b32 v157, 0xffff0000, v14
  v_lshlrev_b32 v158, 16, v15
  v_and_b32 v159, 0xffff0000, v15
  v_add_f32 v24, v144, v145
  v_add_f32 v24, v24, v146
  v_add_f32 v24, v24, v147
  v_add_f32 v24, v24, v148
  v_add_f32 v24, v24, v149
  v_add_f32 v24, v24, v150
  v_add_f32 v24, v24, v151
  v_add_f32 v25, v152, v153
  v_add_f32 v25, v25, v154
  v_add_f32 v25, v25, v155
  v_add_f32 v25, v25, v156
  v_add_f32 v25, v25, v157
  v_add_f32 v25, v25, v158
  v_add_f32 v25, v25, v159
  v_add_f32_dpp v24, v24, v24 row_ror:8 row_mask:0xf bank_mask:0xf
  s_nop 0
  v_add_f32_dpp v25, v25, v25 row_ror:8 row_mask:0xf bank_mask:0xf
  v_add_f32_dpp v24, v24, v24 row_ror:4 row_mask:0xf bank_mask:0xf
  s_nop 0
  v_add_f32_dpp v25, v25, v25 row_ror:4 row_mask:0xf bank_mask:0xf
  v_add_f32_dpp v24, v24, v24 row_ror:2 row_mask:0xf bank_mask:0xf
  s_nop 0
  v_add_f32_dpp v25, v25, v25 row_ror:2 row_mask:0xf bank_mask:0xf
  v_add_f32_dpp v24, v24, v24 row_ror:1 row_mask:0xf bank_mask:0xf
  s_nop 0
  v_add_f32_dpp v25, v25, v25 row_ror:1 row_mask:0xf bank_mask:0xf
  v_mov_b32 v26, v24
  v_mov_b32 v27, v25
  s_nop 0
  v_permlane16_swap_b32 v24, v26
  v_permlane16_swap_b32 v25, v27
  v_add_f32 v24, v24, v26
  v_add_f32 v25, v25, v27
  v_mov_b32 v26, v24
  v_mov_b32 v27, v25
  s_nop 0
  v_permlane32_swap_b32 v24, v26
  v_permlane32_swap_b32 v25, v27
  v_add_f32 v24, v24, v26
  v_add_f32 v25, v25, v27
  v_mul_f32 v24, 0x3b000000, v24
  v_mul_f32 v25, 0x3b000000, v25
  v_sub_f32 v144, v144, v24
  v_sub_f32 v145, v145, v24
  v_sub_f32 v146, v146, v24
  v_sub_f32 v147, v147, v24
  v_sub_f32 v148, v148, v24
  v_sub_f32 v149, v149, v24
  v_sub_f32 v150, v150, v24
  v_sub_f32 v151, v151, v24
  v_mul_f32 v28, v144, v144
  v_fmac_f32 v28, v145, v145
  v_fmac_f32 v28, v146, v146
  v_fmac_f32 v28, v147, v147
  v_fmac_f32 v28, v148, v148
  v_fmac_f32 v28, v149, v149
  v_fmac_f32 v28, v150, v150
  v_fmac_f32 v28, v151, v151
  v_sub_f32 v152, v152, v25
  v_sub_f32 v153, v153, v25
  v_sub_f32 v154, v154, v25
  v_sub_f32 v155, v155, v25
  v_sub_f32 v156, v156, v25
  v_sub_f32 v157, v157, v25
  v_sub_f32 v158, v158, v25
  v_sub_f32 v159, v159, v25
  v_mul_f32 v29, v152, v152
  v_fmac_f32 v29, v153, v153
  v_fmac_f32 v29, v154, v154
  v_fmac_f32 v29, v155, v155
  v_fmac_f32 v29, v156, v156
  v_fmac_f32 v29, v157, v157
  v_fmac_f32 v29, v158, v158
  v_fmac_f32 v29, v159, v159
  v_add_f32_dpp v28, v28, v28 row_ror:8 row_mask:0xf bank_mask:0xf
  s_nop 0
  v_add_f32_dpp v29, v29, v29 row_ror:8 row_mask:0xf bank_mask:0xf
  v_add_f32_dpp v28, v28, v28 row_ror:4 row_mask:0xf bank_mask:0xf
  s_nop 0
  v_add_f32_dpp v29, v29, v29 row_ror:4 row_mask:0xf bank_mask:0xf
  v_add_f32_dpp v28, v28, v28 row_ror:2 row_mask:0xf bank_mask:0xf
  s_nop 0
  v_add_f32_dpp v29, v29, v29 row_ror:2 row_mask:0xf bank_mask:0xf
  v_add_f32_dpp v28, v28, v28 row_ror:1 row_mask:0xf bank_mask:0xf
  s_nop 0
  v_add_f32_dpp v29, v29, v29 row_ror:1 row_mask:0xf bank_mask:0xf
  v_mov_b32 v26, v28
  v_mov_b32 v27, v29
  s_nop 0
  v_permlane16_swap_b32 v28, v26
  v_permlane16_swap_b32 v29, v27
  v_add_f32 v28, v28, v26
  v_add_f32 v29, v29, v27
  v_mov_b32 v26, v28
  v_mov_b32 v27, v29
  s_nop 0
  v_permlane32_swap_b32 v28, v26
  v_permlane32_swap_b32 v29, v27
  v_add_f32 v28, v28, v26
  v_add_f32 v29, v29, v27
  s_mov_b32 s64, 0xaaaaaaaa
  s_mov_b32 s65, 0xaaaaaaaa
  v_cndmask_b32 v24, v24, v25, s[64:65]
  v_cndmask_b32 v28, v28, v29, s[64:65]
  v_mul_f32 v28, 0x3b000000, v28
  v_cvt_pk_bf16_f32 v24, v24, v24
  v_and_b32 v24, 0xffff0000, v24
  v_cvt_pk_bf16_f32 v28, v28, v28
  v_and_b32 v28, 0xffff0000, v28
  v_add_f32 v28, 0x3727c5ac, v28
  v_cvt_pk_bf16_f32 v28, v28, v28
  v_and_b32 v28, 0xffff0000, v28
  v_sqrt_f32 v28, v28
  s_nop 0
  v_cvt_pk_bf16_f32 v28, v28, v28
  v_and_b32 v28, 0xffff0000, v28
  v_rcp_f32 v29, v28
  v_lshlrev_b32 v144, 16, v16
  v_and_b32 v145, 0xffff0000, v16
  v_lshlrev_b32 v146, 16, v17
  v_and_b32 v147, 0xffff0000, v17
  v_lshlrev_b32 v148, 16, v18
  v_and_b32 v149, 0xffff0000, v18
  v_lshlrev_b32 v150, 16, v19
  v_and_b32 v151, 0xffff0000, v19
  v_sub_f32 v144, v144, v24
  v_sub_f32 v145, v145, v24
  v_sub_f32 v146, v146, v24
  v_sub_f32 v147, v147, v24
  v_sub_f32 v148, v148, v24
  v_sub_f32 v149, v149, v24
  v_sub_f32 v150, v150, v24
  v_sub_f32 v151, v151, v24
  v_cvt_pk_bf16_f32 v160, v144, v145
  v_cvt_pk_bf16_f32 v161, v146, v147
  v_cvt_pk_bf16_f32 v162, v148, v149
  v_cvt_pk_bf16_f32 v163, v150, v151
  v_lshlrev_b32 v144, 16, v160
  v_and_b32 v145, 0xffff0000, v160
  v_lshlrev_b32 v146, 16, v161
  v_and_b32 v147, 0xffff0000, v161
  v_lshlrev_b32 v148, 16, v162
  v_and_b32 v149, 0xffff0000, v162
  v_lshlrev_b32 v150, 16, v163
  v_and_b32 v151, 0xffff0000, v163
  v_mul_f32 v160, v144, v29
  v_mul_f32 v161, v145, v29
  v_mul_f32 v162, v146, v29
  v_mul_f32 v163, v147, v29
  v_mul_f32 v164, v148, v29
  v_mul_f32 v165, v149, v29
  v_mul_f32 v166, v150, v29
  v_mul_f32 v167, v151, v29
  v_fma_f32 v144, -v160, v28, v144
  v_fma_f32 v145, -v161, v28, v145
  v_fma_f32 v146, -v162, v28, v146
  v_fma_f32 v147, -v163, v28, v147
  v_fma_f32 v148, -v164, v28, v148
  v_fma_f32 v149, -v165, v28, v149
  v_fma_f32 v150, -v166, v28, v150
  v_fma_f32 v151, -v167, v28, v151
  v_fma_f32 v144, v144, v29, v160
  v_fma_f32 v145, v145, v29, v161
  v_fma_f32 v146, v146, v29, v162
  v_fma_f32 v147, v147, v29, v163
  v_fma_f32 v148, v148, v29, v164
  v_fma_f32 v149, v149, v29, v165
  v_fma_f32 v150, v150, v29, v166
  v_fma_f32 v151, v151, v29, v167
  v_cvt_pk_bf16_f32 v16, v144, v145
  v_cvt_pk_bf16_f32 v17, v146, v147
  v_cvt_pk_bf16_f32 v18, v148, v149
  v_cvt_pk_bf16_f32 v19, v150, v151
  s_mul_i32 s63, s54, 1152
  s_add_u32 s63, s63, 1024
  v_lshl_add_u32 v5, v2, 2, v1
  v_mul_u32_u24 v5, 144, v5
  v_add_u32 v5, s63, v5
  s_lshl_b32 s63, s54, 2
  v_mov_b32 v6, s63
  v_mov_b32 v7, 1
  s_mov_b32 s64, 0x00030003
  s_mov_b32 s65, 0x00030003
  s_waitcnt lgkmcnt(0)
  s_mul_i32 s48, s48, 1664525
  s_add_u32 s48, s48, 1013904223
  v_mov_b32 v251, s48
  v_bfe_u32 v252, v251, 0, 8
  v_bfe_u32 v253, v251, 8, 8
  v_bfe_u32 v254, v251, 16, 8
  v_bfe_u32 v255, v251, 24, 8
  s_waitcnt vmcnt(0)
  v_perm_b32 v224, v68, v64, s50
  v_perm_b32 v225, v76, v72, s50
  v_perm_b32 v226, v84, v80, s50
  v_perm_b32 v227, v92, v88, s50
  v_perm_b32 v228, v68, v64, s51
  v_perm_b32 v229, v76, v72, s51
  v_perm_b32 v230, v84, v80, s51
  v_perm_b32 v231, v92, v88, s51
  v_mfma_f32_16x16x32_bf16 v[32:35], v[224:227], v[16:19], 0
  v_perm_b32 v232, v69, v65, s50
  v_perm_b32 v233, v77, v73, s50
  v_perm_b32 v234, v85, v81, s50
  v_perm_b32 v235, v93, v89, s50
  v_mfma_f32_16x16x32_bf16 v[36:39], v[228:231], v[16:19], 0
  v_perm_b32 v236, v69, v65, s51
  v_perm_b32 v237, v77, v73, s51
  v_perm_b32 v238, v85, v81, s51
  v_perm_b32 v239, v93, v89, s51
  v_mfma_f32_16x16x32_bf16 v[40:43], v[232:235], v[16:19], 0
  v_perm_b32 v224, v70, v66, s50
  v_perm_b32 v225, v78, v74, s50
  v_perm_b32 v226, v86, v82, s50
  v_perm_b32 v227, v94, v90, s50
  v_mfma_f32_16x16x32_bf16 v[44:47], v[236:239], v[16:19], 0
  v_perm_b32 v228, v70, v66, s51
  v_perm_b32 v229, v78, v74, s51
  v_perm_b32 v230, v86, v82, s51
  v_perm_b32 v231, v94, v90, s51
  v_mfma_f32_16x16x32_bf16 v[48:51], v[224:227], v[16:19], 0
  v_perm_b32 v232, v71, v67, s50
  v_perm_b32 v233, v79, v75, s50
  v_perm_b32 v234, v87, v83, s50
  v_perm_b32 v235, v95, v91, s50
  v_mfma_f32_16x16x32_bf16 v[52:55], v[228:231], v[16:19], 0
  v_perm_b32 v236, v71, v67, s51
  v_perm_b32 v237, v79, v75, s51
  v_perm_b32 v238, v87, v83, s51
  v_perm_b32 v239, v95, v91, s51
  v_mfma_f32_16x16x32_bf16 v[56:59], v[232:235], v[16:19], 0
  s_nop 0
  v_mfma_f32_16x16x32_bf16 v[60:63], v[236:239], v[16:19], 0
  s_mov_b64 exec, s[64:65]
  ds_write2_b32 v5, v32, v36 offset0:0 offset1:1
  ds_write2_b32 v5, v40, v44 offset0:2 offset1:3
  ds_write2_b32 v5, v48, v52 offset0:4 offset1:5
  s_nop 3
  ds_write2_b32 v5, v56, v60 offset0:6 offset1:7
  ds_write2_b32 v5, v33, v37 offset0:8 offset1:9
  ds_write2_b32 v5, v41, v45 offset0:10 offset1:11
  ds_write2_b32 v5, v49, v53 offset0:12 offset1:13
  ds_write2_b32 v5, v57, v61 offset0:14 offset1:15
  ds_write2_b32 v5, v34, v38 offset0:16 offset1:17
  ds_write2_b32 v5, v42, v46 offset0:18 offset1:19
  ds_write2_b32 v5, v50, v54 offset0:20 offset1:21
  ds_write2_b32 v5, v58, v62 offset0:22 offset1:23
  ds_write2_b32 v5, v35, v39 offset0:24 offset1:25
  ds_write2_b32 v5, v43, v47 offset0:26 offset1:27
  ds_write2_b32 v5, v51, v55 offset0:28 offset1:29
  ds_write2_b32 v5, v59, v63 offset0:30 offset1:31
  ds_write_b32 v6, v7 offset:6144
  s_mov_b64 exec, -1
  s_cmp_lg_u32 s54, 3
  s_cbranch_scc1 L_pre_done
  v_mov_b32 v6, 0
  v_lshrrev_b32 v8, 3, v0
  v_lshl_add_u32 v8, v8, 4, v3
  s_lshl_b32 s63, s46, 10
  v_add_u32 v60, s63, v3
  s_mov_b32 s67, 1000000
L_rpoll:
  ds_read_b128 v[28:31], v6 offset:6144
  ds_read_b128 v[32:35], v8 offset:1024
  ds_read_b128 v[36:39], v8 offset:2176
  ds_read_b128 v[40:43], v8 offset:3328
  ds_read_b128 v[44:47], v8 offset:4480
  s_waitcnt lgkmcnt(4)
  v_and_b32 v7, v28, v29
  v_and_b32 v7, v7, v30
  v_and_b32 v7, v7, v31
  v_cmp_ne_u32 vcc, 1, v7
  s_cbranch_vccz L_rgo
  s_sub_u32 s67, s67, 1
  s_cbranch_scc0 L_rpoll
L_rgo:
  s_waitcnt lgkmcnt(0)
  v_add_f32 v32, v32, v36
  v_add_f32 v40, v40, v44
  v_add_f32 v33, v33, v37
  v_add_f32 v41, v41, v45
  v_add_f32 v34, v34, v38
  v_add_f32 v42, v42, v46
  v_add_f32 v35, v35, v39
  v_add_f32 v43, v43, v47
  v_add_f32 v56, v32, v40
  v_add_f32 v57, v33, v41
  v_add_f32 v58, v34, v42
  v_add_f32 v59, v35, v43
  v_add_u32 v56, 0x80, v56
  v_add_u32 v57, 0x80, v57
  v_add_u32 v58, 0x80, v58
  v_add_u32 v59, 0x80, v59
  v_bfi_b32 v56, s49, v252, v56
  v_bfi_b32 v57, s49, v253, v57
  v_bfi_b32 v58, s49, v254, v58
  v_bfi_b32 v59, s49, v255, v59
  global_store_dwordx4 v60, v[56:59], s[38:39] sc1
  s_branch L_pre_done
L_nopre:
  s_waitcnt lgkmcnt(0)
  s_mul_i32 s48, s48, 1664525
  s_add_u32 s48, s48, 1013904223
  v_mov_b32 v251, s48
  v_bfe_u32 v252, v251, 0, 8
  v_bfe_u32 v253, v251, 8, 8
  v_bfe_u32 v254, v251, 16, 8
  v_bfe_u32 v255, v251, 24, 8
  s_sleep 40
L_pre_done:
  s_lshl_b32 s63, s7, 2
  s_add_u32 s63, s63, s54
  s_lshl_b32 s64, s63, 12
  s_lshl_b32 s65, s6, 9
  s_add_u32 s64, s64, s65
  v_lshrrev_b32 v5, 5, v0
  v_lshl_add_u32 v5, v5, 10, s64
  v_and_b32 v8, 31, v0
  v_lshl_add_u32 v5, v8, 4, v5
  s_lshl_b32 s64, s54, 8
  v_lshl_add_u32 v8, v8, 3, s64
  s_sleep 40
  s_mov_b32 s67, 1000000
L_pq:
  global_load_dwordx4 v[32:35], v5, s[38:39] sc1
  global_load_dwordx4 v[36:39], v5, s[38:39] offset:2048 sc1
  s_waitcnt vmcnt(0)
  v_xor_b32 v32, v32, v252
  v_xor_b32 v33, v33, v253
  v_xor_b32 v34, v34, v254
  v_xor_b32 v35, v35, v255
  v_or_b32 v6, v32, v33
  v_or_b32 v7, v34, v35
  v_xor_b32 v36, v36, v252
  v_xor_b32 v37, v37, v253
  v_xor_b32 v38, v38, v254
  v_xor_b32 v39, v39, v255
  v_or3_b32 v6, v6, v36, v37
  v_or3_b32 v7, v7, v38, v39
  v_or_b32 v6, v6, v7
  v_and_b32 v6, s49, v6
  v_cmp_ne_u32 vcc, 0, v6
  s_cbranch_vccz L_gq
  s_sub_u32 s67, s67, 1
  s_sleep 4
  s_cbranch_scc0 L_pq
L_gq:
  v_add_f32 v32, v32, v36
  v_add_f32 v33, v33, v37
  v_add_f32 v34, v34, v38
  v_add_f32 v35, v35, v39
  v_mov_b32 v36, v32
  v_mov_b32 v37, v33
  v_mov_b32 v38, v34
  v_mov_b32 v39, v35
  v_permlane32_swap_b32 v32, v36
  v_permlane32_swap_b32 v33, v37
  v_permlane32_swap_b32 v34, v38
  v_permlane32_swap_b32 v35, v39
  v_add_f32 v32, v32, v36
  v_add_f32 v33, v33, v37
  v_add_f32 v34, v34, v38
  v_add_f32 v35, v35, v39
  v_cvt_pk_bf16_f32 v32, v32, v33
  v_cvt_pk_bf16_f32 v33, v34, v35
  ds_write_b64 v8, v[32:33] offset:0
  s_mov_b64 exec, 1
  v_mov_b32 v6, 6160
  v_mov_b32 v7, 1
  ds_add_u32 v6, v7 offset:8
  s_mov_b64 exec, -1
  s_cmp_ge_u32 s54, 2
  s_cbranch_scc1 L_merge
  s_cmp_lt_u32 s2, 64
  s_cbranch_scc1 L_final
  s_sub_u32 s66, s2, 64
  s_add_u32 s63, s66, 192
  s_cmp_eq_u32 s54, 0
  s_cselect_b32 s66, s63, s66
  s_cmp_ge_u32 s66, 224
  s_cbranch_scc1 L_fin
  s_and_b32 s69, s66, 3
  s_lshr_b32 s66, s66, 2
  v_lshlrev_b32 v4, 13, v1
  v_lshl_add_u32 v4, v2, 4, v4
  s_mov_b32 s40, s32
  s_and_b32 s41, s33, 0xffff
  s_mov_b32 s42, 1835008
  s_mov_b32 s43, 0x20000
  s_lshl_b32 s56, s66, 15
  s_lshl_b32 s57, s69, 8
  s_add_u32 s56, s56, s57
  s_add_u32 s57, s56, 4096
  s_and_b32 s63, s66, 0xfc
  s_add_u32 s63, s63, 64
  s_lshl_b32 s63, s63, 11
  s_and_b32 s64, s66, 3
  s_lshl_b32 s64, s64, 7
  s_add_u32 s63, s63, s64
  v_lshl_add_u32 v5, v1, 10, s63
  v_bfe_u32 v13, v0, 3, 1
  v_lshl_add_u32 v5, v13, 9, v5
  v_and_b32 v8, 7, v0
  v_lshl_add_u32 v5, v8, 4, v5
  v_add_u32 v9, 0x1000, v5
  s_lshl_b32 s63, s54, 7
  v_lshl_add_u32 v10, v2, 3, s63
  v_lshl_add_u32 v11, v13, 6, s63
  v_lshl_add_u32 v11, v1, 4, v11
  v_mov_b32 v96, 0
  v_mov_b32 v97, 0
  v_mov_b32 v98, 0
  v_mov_b32 v99, 0
  v_mov_b32 v100, 0
  v_mov_b32 v101, 0
  v_mov_b32 v102, 0
  v_mov_b32 v103, 0
  v_mov_b32 v104, 0
  v_mov_b32 v105, 0
  v_mov_b32 v106, 0
  v_mov_b32 v107, 0
  v_mov_b32 v108, 0
  v_mov_b32 v109, 0
  v_mov_b32 v110, 0
  v_mov_b32 v111, 0
  v_mov_b32 v112, 0
  v_mov_b32 v113, 0
  v_mov_b32 v114, 0
  v_mov_b32 v115, 0
  v_mov_b32 v116, 0
  v_mov_b32 v117, 0
  v_mov_b32 v118, 0
  v_mov_b32 v119, 0
  v_mov_b32 v120, 0
  v_mov_b32 v121, 0
  v_mov_b32 v122, 0
  v_mov_b32 v123, 0
  v_mov_b32 v124, 0
  v_mov_b32 v125, 0
  v_mov_b32 v126, 0
  v_mov_b32 v127, 0
  s_lshl_b32 s63, s69, 3
  v_bfe_u32 v6, v0, 3, 1
  v_lshl_add_u32 v12, v6, 5, s63
  v_lshl_add_u32 v12, v1, 1, v12
  v_bfe_u32 v6, v0, 2, 1
  v_add_u32 v12, v12, v6
  v_lshl_add_u32 v12, v12, 6, s66
  v_lshlrev_b32 v12, 6, v12
  v_and_b32 v6, 3, v0
  v_lshl_add_u32 v12, v6, 4, v12
  v_add_u32 v12, 1835008, v12
  s_sleep 60
  s_mov_b32 s67, 1000000
L_pf:
  global_load_dwordx4 v[128:131], v5, s[38:39] sc1
  global_load_dwordx4 v[132:135], v9, s[38:39] sc1
  s_waitcnt vmcnt(0)
  v_xor_b32 v128, v128, v252
  v_xor_b32 v129, v129, v253
  v_xor_b32 v130, v130, v254
  v_xor_b32 v131, v131, v255
  v_or_b32 v6, v128, v129
  v_or_b32 v7, v130, v131
  v_xor_b32 v132, v132, v252
  v_xor_b32 v133, v133, v253
  v_xor_b32 v134, v134, v254
  v_xor_b32 v135, v135, v255
  v_or3_b32 v6, v6, v132, v133
  v_or3_b32 v7, v7, v134, v135
  v_or_b32 v6, v6, v7
  v_and_b32 v6, s49, v6
  v_cmp_ne_u32 vcc, 0, v6
  s_cbranch_vccz L_gf
  s_sub_u32 s67, s67, 1
  s_sleep 16
  s_cbranch_scc0 L_pf
L_gf:
  v_mov_b32 v136, v128
  v_mov_b32 v137, v129
  v_mov_b32 v138, v130
  v_mov_b32 v139, v131
  v_mov_b32 v140, v132
  v_mov_b32 v141, v133
  v_mov_b32 v142, v134
  v_mov_b32 v143, v135
  v_permlane16_swap_b32 v128, v136
  v_permlane16_swap_b32 v129, v137
  v_permlane16_swap_b32 v130, v138
  v_permlane16_swap_b32 v131, v139
  v_permlane16_swap_b32 v132, v140
  v_permlane16_swap_b32 v133, v141
  v_permlane16_swap_b32 v134, v142
  v_permlane16_swap_b32 v135, v143
  v_add_f32 v128, v128, v136
  v_add_f32 v129, v129, v137
  v_add_f32 v130, v130, v138
  v_add_f32 v131, v131, v139
  v_add_f32 v132, v132, v140
  v_add_f32 v133, v133, v141
  v_add_f32 v134, v134, v142
  v_add_f32 v135, v135, v143
  v_mov_b32 v136, v128
  v_mov_b32 v137, v129
  v_mov_b32 v138, v130
  v_mov_b32 v139, v131
  v_mov_b32 v140, v132
  v_mov_b32 v141, v133
  v_mov_b32 v142, v134
  v_mov_b32 v143, v135
  v_permlane32_swap_b32 v128, v136
  v_permlane32_swap_b32 v129, v137
  v_permlane32_swap_b32 v130, v138
  v_permlane32_swap_b32 v131, v139
  v_permlane32_swap_b32 v132, v140
  v_permlane32_swap_b32 v133, v141
  v_permlane32_swap_b32 v134, v142
  v_permlane32_swap_b32 v135, v143
  v_add_f32 v128, v128, v136
  v_add_f32 v129, v129, v137
  v_add_f32 v130, v130, v138
  v_add_f32 v131, v131, v139
  v_add_f32 v132, v132, v140
  v_add_f32 v133, v133, v141
  v_add_f32 v134, v134, v142
  v_add_f32 v135, v135, v143
  v_cvt_pk_bf16_f32 v184, v128, v129
  v_cvt_pk_bf16_f32 v185, v130, v131
  v_cvt_pk_bf16_f32 v186, v132, v133
  v_cvt_pk_bf16_f32 v187, v134, v135
  v_lshlrev_b32 v128, 16, v184
  v_and_b32 v129, 0xffff0000, v184
  v_lshlrev_b32 v130, 16, v185
  v_and_b32 v131, 0xffff0000, v185
  v_lshlrev_b32 v132, 16, v186
  v_and_b32 v133, 0xffff0000, v186
  v_lshlrev_b32 v134, 16, v187
  v_and_b32 v135, 0xffff0000, v187
  s_mov_b32 s63, 0xbdd2d3e8
  v_mov_b32 v188, 0xc0135761
  v_mul_f32 v176, v128, v128
  v_mul_f32 v177, v129, v129
  v_mul_f32 v178, v130, v130
  v_mul_f32 v179, v131, v131
  v_fma_f32 v176, v176, s63, v188
  v_fma_f32 v177, v177, s63, v188
  v_fma_f32 v178, v178, s63, v188
  v_fma_f32 v179, v179, s63, v188
  v_mul_f32 v176, v176, v128
  v_mul_f32 v177, v177, v129
  v_mul_f32 v178, v178, v130
  v_mul_f32 v179, v179, v131
  v_exp_f32 v176, v176
  v_exp_f32 v177, v177
  v_exp_f32 v178, v178
  v_exp_f32 v179, v179
  v_add_f32 v176, 1.0, v176
  v_add_f32 v177, 1.0, v177
  v_add_f32 v178, 1.0, v178
  v_add_f32 v179, 1.0, v179
  v_rcp_f32 v176, v176
  v_rcp_f32 v177, v177
  v_rcp_f32 v178, v178
  v_rcp_f32 v179, v179
  v_mul_f32 v128, v128, v176
  v_mul_f32 v129, v129, v177
  v_mul_f32 v130, v130, v178
  v_mul_f32 v131, v131, v179
  v_cvt_pk_bf16_f32 v184, v128, v129
  v_cvt_pk_bf16_f32 v185, v130, v131
  v_lshlrev_b32 v128, 16, v184
  v_and_b32 v129, 0xffff0000, v184
  v_lshlrev_b32 v130, 16, v185
  v_and_b32 v131, 0xffff0000, v185
  v_mul_f32 v128, v128, v132
  v_mul_f32 v129, v129, v133
  v_mul_f32 v130, v130, v134
  v_mul_f32 v131, v131, v135
  v_cvt_pk_bf16_f32 v136, v128, v129
  v_cvt_pk_bf16_f32 v137, v130, v131
  ds_write_b64 v10, v[136:137] offset:6400
  s_mov_b32 exec_lo, 0x01010101
  s_mov_b32 exec_hi, 0x01010101
  ds_read_b128 v[96:99], v11 offset:6400
  s_mov_b32 exec_lo, 0x02020202
  s_mov_b32 exec_hi, 0x02020202
  ds_read_b128 v[100:103], v11 offset:6400
  s_mov_b32 exec_lo, 0x04040404
  s_mov_b32 exec_hi, 0x04040404
  ds_read_b128 v[104:107], v11 offset:6400
  s_mov_b32 exec_lo, 0x08080808
  s_mov_b32 exec_hi, 0x08080808
  ds_read_b128 v[108:111], v11 offset:6400
  s_mov_b32 exec_lo, 0x10101010
  s_mov_b32 exec_hi, 0x10101010
  ds_read_b128 v[112:115], v11 offset:6400
  s_mov_b32 exec_lo, 0x20202020
  s_mov_b32 exec_hi, 0x20202020
  ds_read_b128 v[116:119], v11 offset:6400
  s_mov_b32 exec_lo, 0x40404040
  s_mov_b32 exec_hi, 0x40404040
  ds_read_b128 v[120:123], v11 offset:6400
  s_mov_b32 exec_lo, 0x80808080
  s_mov_b32 exec_hi, 0x80808080
  ds_read_b128 v[124:127], v11 offset:6400
  s_mov_b64 exec, -1
  s_waitcnt lgkmcnt(0)
  v_mov_b32 v6, 6160
  s_mov_b32 s67, 8000000
L_twf:
  s_sleep 3
  ds_read_b32 v7, v6
  s_sub_u32 s67, s67, 1
  s_cbranch_scc1 L_txf
  s_waitcnt lgkmcnt(0)
  v_readfirstlane_b32 s63, v7
  s_nop 0
  s_cmp_lt_u32 s63, 4
  s_cbranch_scc1 L_twf
L_txf:
  buffer_load_dwordx4 v[64:67], v4, s[40:43], s56 offen offset:0 nt
  buffer_load_dwordx4 v[68:71], v4, s[40:43], s56 offen offset:1024 nt
  buffer_load_dwordx4 v[72:75], v4, s[40:43], s56 offen offset:2048 nt
  buffer_load_dwordx4 v[76:79], v4, s[40:43], s56 offen offset:3072 nt
  buffer_load_dwordx4 v[80:83], v4, s[40:43], s57 offen offset:0 nt
  buffer_load_dwordx4 v[84:87], v4, s[40:43], s57 offen offset:1024 nt
  buffer_load_dwordx4 v[88:91], v4, s[40:43], s57 offen offset:2048 nt
  buffer_load_dwordx4 v[92:95], v4, s[40:43], s57 offen offset:3072 nt
  s_barrier
  s_waitcnt vmcnt(0)
  v_perm_b32 v144, v68, v64, s50
  v_perm_b32 v145, v76, v72, s50
  v_perm_b32 v146, v84, v80, s50
  v_perm_b32 v147, v92, v88, s50
  v_perm_b32 v148, v68, v64, s51
  v_perm_b32 v149, v76, v72, s51
  v_perm_b32 v150, v84, v80, s51
  v_perm_b32 v151, v92, v88, s51
  v_mfma_f32_16x16x32_bf16 v[32:35], v[144:147], v[96:99], 0
  v_perm_b32 v152, v69, v65, s50
  v_perm_b32 v153, v77, v73, s50
  v_perm_b32 v154, v85, v81, s50
  v_perm_b32 v155, v93, v89, s50
  v_mfma_f32_16x16x32_bf16 v[32:35], v[148:151], v[100:103], v[32:35]
  v_perm_b32 v156, v69, v65, s51
  v_perm_b32 v157, v77, v73, s51
  v_perm_b32 v158, v85, v81, s51
  v_perm_b32 v159, v93, v89, s51
  v_mfma_f32_16x16x32_bf16 v[32:35], v[152:155], v[104:107], v[32:35]
  v_perm_b32 v160, v70, v66, s50
  v_perm_b32 v161, v78, v74, s50
  v_perm_b32 v162, v86, v82, s50
  v_perm_b32 v163, v94, v90, s50
  v_mfma_f32_16x16x32_bf16 v[32:35], v[156:159], v[108:111], v[32:35]
  v_perm_b32 v164, v70, v66, s51
  v_perm_b32 v165, v78, v74, s51
  v_perm_b32 v166, v86, v82, s51
  v_perm_b32 v167, v94, v90, s51
  v_mfma_f32_16x16x32_bf16 v[32:35], v[160:163], v[112:115], v[32:35]
  v_perm_b32 v168, v71, v67, s50
  v_perm_b32 v169, v79, v75, s50
  v_perm_b32 v170, v87, v83, s50
  v_perm_b32 v171, v95, v91, s50
  v_mfma_f32_16x16x32_bf16 v[32:35], v[164:167], v[116:119], v[32:35]
  v_perm_b32 v172, v71, v67, s51
  v_perm_b32 v173, v79, v75, s51
  v_perm_b32 v174, v87, v83, s51
  v_perm_b32 v175, v95, v91, s51
  v_mfma_f32_16x16x32_bf16 v[32:35], v[168:171], v[120:123], v[32:35]
  s_nop 0
  v_mfma_f32_16x16x32_bf16 v[32:35], v[172:175], v[124:127], v[32:35]
  s_nop 7
  v_bfi_b32 v32, s49, v252, v32
  v_bfi_b32 v33, s49, v253, v33
  v_bfi_b32 v34, s49, v254, v34
  v_bfi_b32 v35, s49, v255, v35
  global_store_dwordx4 v12, v[32:35], s[38:39] sc1
  s_branch L_fin
L_final:
  s_mov_b32 s70, 0x00f000f0
  s_mov_b32 s71, 0x00f000f0
  s_mov_b32 s72, 0x0f000f00
  s_mov_b32 s73, 0x0f000f00
  s_mov_b32 s74, 0xf000f000
  s_mov_b32 s75, 0xf000f000
  v_lshlrev_b32 v17, 2, v2
  s_cmp_eq_u32 s54, 0
  s_cbranch_scc1 L_final_s
  s_lshl_b32 s63, s2, 12
  s_add_u32 s63, s63, 1835008
  v_add_u32 v14, s63, v3
  s_barrier
  v_mov_b32 v6, 6172
  s_mov_b32 s67, 8000000
L_twy2:
  s_sleep 1
  ds_read_b32 v7, v6
  s_sub_u32 s67, s67, 1
  s_cbranch_scc1 L_txy2
  s_waitcnt lgkmcnt(0)
  v_readfirstlane_b32 s63, v7
  s_nop 0
  s_cmp_lt_u32 s63, 1
  s_cbranch_scc1 L_twy2
L_txy2:
  s_mov_b32 s67, 1000000
L_py:
  v_mov_b32 v64, v252
  v_mov_b32 v65, v253
  v_mov_b32 v66, v254
  v_mov_b32 v67, v255
  s_mov_b32 s76, exec_hi
  s_mov_b32 exec_hi, 0
  s_cbranch_execz L_yskip
  global_load_dwordx4 v[64:67], v14, s[38:39] offset:3072 sc1
L_yskip:
  s_mov_b32 exec_hi, s76
  global_load_dwordx4 v[68:71], v14, s[38:39] offset:0 sc1
  global_load_dwordx4 v[72:75], v14, s[38:39] offset:1024 sc1
  global_load_dwordx4 v[76:79], v14, s[38:39] offset:2048 sc1
  s_waitcnt vmcnt(3)
  v_xor_b32 v64, v64, v252
  v_xor_b32 v65, v65, v253
  v_xor_b32 v66, v66, v254
  v_xor_b32 v67, v67, v255
  v_or_b32 v6, v64, v65
  v_or_b32 v7, v66, v67
  s_waitcnt vmcnt(2)
  v_xor_b32 v68, v68, v252
  v_xor_b32 v69, v69, v253
  v_xor_b32 v70, v70, v254
  v_xor_b32 v71, v71, v255
  v_or3_b32 v6, v6, v68, v69
  v_or3_b32 v7, v7, v70, v71
  v_pk_add_f32 v[20:21], v[64:65], v[68:69]
  v_pk_add_f32 v[22:23], v[66:67], v[70:71]
  s_waitcnt vmcnt(1)
  v_xor_b32 v72, v72, v252
  v_xor_b32 v73, v73, v253
  v_xor_b32 v74, v74, v254
  v_xor_b32 v75, v75, v255
  v_or3_b32 v6, v6, v72, v73
  v_or3_b32 v7, v7, v74, v75
  v_pk_add_f32 v[20:21], v[20:21], v[72:73]
  v_pk_add_f32 v[22:23], v[22:23], v[74:75]
  s_waitcnt vmcnt(0)
  v_xor_b32 v76, v76, v252
  v_xor_b32 v77, v77, v253
  v_xor_b32 v78, v78, v254
  v_xor_b32 v79, v79, v255
  v_or3_b32 v6, v6, v76, v77
  v_or3_b32 v7, v7, v78, v79
  v_pk_add_f32 v[20:21], v[20:21], v[76:77]
  v_pk_add_f32 v[22:23], v[22:23], v[78:79]
  v_or_b32 v6, v6, v7
  v_and_b32 v6, s49, v6
  v_cmp_ne_u32 vcc, 0, v6
  s_cbranch_vccz L_gy
  s_mov_b64 exec, vcc
  s_sub_u32 s67, s67, 1
  s_sleep 2
  s_cbranch_scc0 L_py
L_gy:
  s_mov_b64 exec, -1
  v_add_f32_dpp v20, v20, v20 row_ror:4 row_mask:0xf bank_mask:0xf
  v_add_f32_dpp v21, v21, v21 row_ror:4 row_mask:0xf bank_mask:0xf
  v_add_f32_dpp v22, v22, v22 row_ror:4 row_mask:0xf bank_mask:0xf
  v_add_f32_dpp v23, v23, v23 row_ror:4 row_mask:0xf bank_mask:0xf
  v_add_f32_dpp v20, v20, v20 row_ror:8 row_mask:0xf bank_mask:0xf
  v_add_f32_dpp v21, v21, v21 row_ror:8 row_mask:0xf bank_mask:0xf
  v_add_f32_dpp v22, v22, v22 row_ror:8 row_mask:0xf bank_mask:0xf
  v_add_f32_dpp v23, v23, v23 row_ror:8 row_mask:0xf bank_mask:0xf
  v_cndmask_b32 v12, v20, v21, s[70:71]
  v_cndmask_b32 v12, v12, v22, s[72:73]
  v_cndmask_b32 v12, v12, v23, s[74:75]
  v_mov_b32 v24, v12
  s_nop 1
  v_permlane16_swap_b32 v12, v24
  v_add_f32 v12, v12, v24
  v_mov_b32 v24, v12
  s_nop 1
  v_permlane32_swap_b32 v12, v24
  v_add_f32 v12, v12, v24
  v_cvt_pk_bf16_f32 v12, v12, v12
  v_and_b32 v12, 0xffff0000, v12
  v_mul_f32 v13, 0xbfb8aa3b, v12
  v_exp_f32 v13, v13
  s_nop 0
  v_add_f32 v13, 1.0, v13
  v_rcp_f32 v13, v13
  s_nop 0
  v_mul_f32 v12, v12, v13
  v_cvt_pk_bf16_f32 v12, v12, v12
  v_and_b32 v12, 0xffff0000, v12
  v_or_b32 v12, 1, v12
  ds_write_b32 v17, v12 offset:6176
  s_branch L_fin
L_final_s:
  s_lshr_b32 s63, s2, 1
  s_lshl_b32 s63, s63, 5
  s_and_b32 s64, s2, 1
  s_lshl_b32 s64, s64, 2
  s_add_u32 s63, s63, s64
  v_bfe_u32 v10, v0, 2, 2
  v_lshl_add_u32 v10, v10, 3, s63
  v_and_b32 v11, 3, v0
  v_add_lshl_u32 v10, v10, v11, 1
  global_load_ushort v11, v10, s[16:17]
  s_lshl_b32 s63, s2, 13
  s_add_u32 s63, s63, 1310720
  v_add_u32 v15, s63, v3
  v_add_u32 v16, 0x1000, v15
  s_waitcnt vmcnt(0)
  v_lshlrev_b32 v11, 16, v11
  s_barrier
  s_mov_b32 s67, 1000000
L_ps:
  global_load_dwordx4 v[64:67], v15, s[38:39] offset:0 sc1
  global_load_dwordx4 v[68:71], v15, s[38:39] offset:1024 sc1
  global_load_dwordx4 v[72:75], v15, s[38:39] offset:2048 sc1
  global_load_dwordx4 v[76:79], v15, s[38:39] offset:3072 sc1
  global_load_dwordx4 v[80:83], v16, s[38:39] offset:0 sc1
  global_load_dwordx4 v[84:87], v16, s[38:39] offset:1024 sc1
  global_load_dwordx4 v[88:91], v16, s[38:39] offset:2048 sc1
  global_load_dwordx4 v[92:95], v16, s[38:39] offset:3072 sc1
  s_waitcnt vmcnt(7)
  v_xor_b32 v64, v64, v252
  v_xor_b32 v65, v65, v253
  v_xor_b32 v66, v66, v254
  v_xor_b32 v67, v67, v255
  v_or_b32 v6, v64, v65
  v_or_b32 v7, v66, v67
  s_waitcnt vmcnt(6)
  v_xor_b32 v68, v68, v252
  v_xor_b32 v69, v69, v253
  v_xor_b32 v70, v70, v254
  v_xor_b32 v71, v71, v255
  v_or3_b32 v6, v6, v68, v69
  v_or3_b32 v7, v7, v70, v71
  v_pk_add_f32 v[20:21], v[64:65], v[68:69]
  v_pk_add_f32 v[22:23], v[66:67], v[70:71]
  s_waitcnt vmcnt(5)
  v_xor_b32 v72, v72, v252
  v_xor_b32 v73, v73, v253
  v_xor_b32 v74, v74, v254
  v_xor_b32 v75, v75, v255
  v_or3_b32 v6, v6, v72, v73
  v_or3_b32 v7, v7, v74, v75
  v_pk_add_f32 v[20:21], v[20:21], v[72:73]
  v_pk_add_f32 v[22:23], v[22:23], v[74:75]
  s_waitcnt vmcnt(4)
  v_xor_b32 v76, v76, v252
  v_xor_b32 v77, v77, v253
  v_xor_b32 v78, v78, v254
  v_xor_b32 v79, v79, v255
  v_or3_b32 v6, v6, v76, v77
  v_or3_b32 v7, v7, v78, v79
  v_pk_add_f32 v[20:21], v[20:21], v[76:77]
  v_pk_add_f32 v[22:23], v[22:23], v[78:79]
  s_waitcnt vmcnt(3)
  v_xor_b32 v80, v80, v252
  v_xor_b32 v81, v81, v253
  v_xor_b32 v82, v82, v254
  v_xor_b32 v83, v83, v255
  v_or3_b32 v6, v6, v80, v81
  v_or3_b32 v7, v7, v82, v83
  v_pk_add_f32 v[20:21], v[20:21], v[80:81]
  v_pk_add_f32 v[22:23], v[22:23], v[82:83]
  s_waitcnt vmcnt(2)
  v_xor_b32 v84, v84, v252
  v_xor_b32 v85, v85, v253
  v_xor_b32 v86, v86, v254
  v_xor_b32 v87, v87, v255
  v_or3_b32 v6, v6, v84, v85
  v_or3_b32 v7, v7, v86, v87
  v_pk_add_f32 v[20:21], v[20:21], v[84:85]
  v_pk_add_f32 v[22:23], v[22:23], v[86:87]
  s_waitcnt vmcnt(1)
  v_xor_b32 v88, v88, v252
  v_xor_b32 v89, v89, v253
  v_xor_b32 v90, v90, v254
  v_xor_b32 v91, v91, v255
  v_or3_b32 v6, v6, v88, v89
  v_or3_b32 v7, v7, v90, v91
  v_pk_add_f32 v[20:21], v[20:21], v[88:89]
  v_pk_add_f32 v[22:23], v[22:23], v[90:91]
  s_waitcnt vmcnt(0)
  v_xor_b32 v92, v92, v252
  v_xor_b32 v93, v93, v253
  v_xor_b32 v94, v94, v254
  v_xor_b32 v95, v95, v255
  v_or3_b32 v6, v6, v92, v93
  v_or3_b32 v7, v7, v94, v95
  v_pk_add_f32 v[20:21], v[20:21], v[92:93]
  v_pk_add_f32 v[22:23], v[22:23], v[94:95]
  v_or_b32 v6, v6, v7
  v_and_b32 v6, s49, v6
  v_cmp_ne_u32 vcc, 0, v6
  s_cbranch_vccz L_gs
  s_mov_b64 exec, vcc
  s_sub_u32 s67, s67, 1
  s_cbranch_scc0 L_ps
L_gs:
  s_mov_b64 exec, -1
  ds_read_b32 v12, v17 offset:6176
  v_add_f32_dpp v20, v20, v20 row_ror:4 row_mask:0xf bank_mask:0xf
  v_add_f32_dpp v21, v21, v21 row_ror:4 row_mask:0xf bank_mask:0xf
  v_add_f32_dpp v22, v22, v22 row_ror:4 row_mask:0xf bank_mask:0xf
  v_add_f32_dpp v23, v23, v23 row_ror:4 row_mask:0xf bank_mask:0xf
  v_add_f32_dpp v20, v20, v20 row_ror:8 row_mask:0xf bank_mask:0xf
  v_add_f32_dpp v21, v21, v21 row_ror:8 row_mask:0xf bank_mask:0xf
  v_add_f32_dpp v22, v22, v22 row_ror:8 row_mask:0xf bank_mask:0xf
  v_add_f32_dpp v23, v23, v23 row_ror:8 row_mask:0xf bank_mask:0xf
  v_cndmask_b32 v13, v20, v21, s[70:71]
  v_cndmask_b32 v13, v13, v22, s[72:73]
  v_cndmask_b32 v13, v13, v23, s[74:75]
  v_mov_b32 v24, v13
  s_nop 1
  v_permlane16_swap_b32 v13, v24
  v_add_f32 v13, v13, v24
  v_mov_b32 v24, v13
  s_nop 1
  v_permlane32_swap_b32 v13, v24
  v_add_f32 v13, v13, v24
  v_cvt_pk_bf16_f32 v13, v13, v13
  v_and_b32 v13, 0xffff0000, v13
  s_mov_b32 s67, 8000000
L_gw:
  s_waitcnt lgkmcnt(0)
  v_and_b32 v14, 1, v12
  v_cmp_ne_u32 vcc, 1, v14
  s_cbranch_vccz L_gg
  ds_read_b32 v12, v17 offset:6176
  s_sub_u32 s67, s67, 1
  s_cbranch_scc0 L_gw
  s_waitcnt lgkmcnt(0)
L_gg:
  v_and_b32 v12, 0xffff0000, v12
  v_mul_f32 v13, v13, v12
  v_cvt_pk_bf16_f32 v13, v13, v13
  v_and_b32 v13, 0xffff0000, v13
  v_add_f32 v13, v13, v11
  v_cvt_pk_bf16_f32 v13, v13, v13
  s_mov_b64 exec, 0xffff
  global_store_short v10, v13, s[34:35]
  s_cmp_lg_u32 s2, 0
  s_cbranch_scc1 L_fin
  s_mov_b64 exec, 1
  v_mov_b32 v10, 258048
  global_store_dword v10, v251, s[38:39]
  s_branch L_fin
L_merge:
  s_sub_u32 s70, s54, 2
  v_lshrrev_b32 v5, 5, v0
  v_lshl_add_u32 v5, s70, 1, v5
  v_and_b32 v8, 31, v0
  v_lshlrev_b32 v44, 4, v5
  v_mul_u32_u24 v45, 528, v5
  v_lshl_add_u32 v45, v8, 4, v45
  s_lshl_b32 s63, s7, 2
  v_add_u32 v5, s63, v5
  v_lshrrev_b32 v46, 3, v8
  v_lshl_add_u32 v46, v5, 2, v46
  v_lshl_add_u32 v46, v46, 5, s47
  v_lshlrev_b32 v46, 7, v46
  v_add_u32 v46, 262144, v46
  v_and_b32 v8, 7, v0
  v_lshl_add_u32 v46, v8, 4, v46
  s_lshl_b32 s63, s7, 1
  s_add_u32 s63, s63, s70
  s_lshl_b32 s63, s63, 5
  s_add_u32 s63, s63, s47
  s_lshl_b32 s63, s63, 7
  s_add_u32 s63, s63, 786432
  v_lshrrev_b32 v47, 5, v0
  v_lshl_add_u32 v47, v47, 6, s63
  v_lshl_add_u32 v47, v8, 3, v47
  v_mov_b32 v55, v251
  s_lshr_b32 s68, s47, 2
  s_lshl_b32 s64, s7, 3
  s_add_u32 s68, s68, s64
  s_lshl_b32 s68, s68, 1
  s_add_u32 s68, s68, s70
  s_and_b32 s69, s47, 3
  s_mov_b32 s40, s24
  s_and_b32 s41, s25, 0xffff
  s_mov_b32 s42, 4194304
  s_mov_b32 s43, 0x20000
  s_lshl_b32 s56, s68, 15
  s_lshl_b32 s57, s69, 8
  s_add_u32 s56, s56, s57
  v_lshlrev_b32 v4, 11, v1
  v_lshl_add_u32 v4, v2, 4, v4
  v_lshrrev_b32 v48, 5, v0
  v_lshlrev_b32 v48, 4, v48
  v_and_b32 v8, 12, v0
  v_add_u32 v48, v48, v8
  s_lshr_b32 s63, s68, 3
  s_lshl_b32 s63, s63, 5
  v_add_lshl_u32 v49, v48, s63, 7
  s_bfe_u32 s63, s68, 0x10002
  s_lshl_b32 s63, s63, 6
  s_add_u32 s63, s63, 786432
  v_add_u32 v49, s63, v49
  s_lshl_b32 s63, s68, 5
  v_add_lshl_u32 v48, v48, s63, 7
  v_add_u32 v48, 262144, v48
  v_bfe_u32 v8, v0, 4, 1
  v_and_b32 v9, 3, v0
  v_lshl_add_u32 v8, v8, 2, v9
  v_lshl_add_u32 v48, v8, 4, v48
  s_lshl_b32 s63, s70, 7
  s_add_u32 s63, s63, 17152
  v_lshrrev_b32 v9, 5, v0
  v_lshl_add_u32 v50, v9, 6, s63
  v_lshl_add_u32 v50, v8, 3, v50
  v_bfe_u32 v9, v0, 3, 1
  v_lshl_add_u32 v51, v9, 6, s63
  v_lshl_add_u32 v51, v1, 4, v51
  s_lshl_b32 s63, s69, 3
  v_bfe_u32 v6, v0, 3, 1
  v_lshl_add_u32 v52, v6, 5, s63
  v_lshl_add_u32 v52, v1, 1, v52
  v_bfe_u32 v6, v0, 2, 1
  v_add_u32 v52, v52, v6
  v_lshl_add_u32 v52, v52, 7, s68
  v_lshlrev_b32 v52, 6, v52
  v_and_b32 v6, 3, v0
  v_lshl_add_u32 v52, v6, 4, v52
  v_add_u32 v52, 1310720, v52
  v_mov_b32 v53, 6172
  v_mov_b32 v96, 0
  v_mov_b32 v97, 0
  v_mov_b32 v98, 0
  v_mov_b32 v99, 0
  v_mov_b32 v100, 0
  v_mov_b32 v101, 0
  v_mov_b32 v102, 0
  v_mov_b32 v103, 0
  v_mov_b32 v104, 0
  v_mov_b32 v105, 0
  v_mov_b32 v106, 0
  v_mov_b32 v107, 0
  v_mov_b32 v108, 0
  v_mov_b32 v109, 0
  v_mov_b32 v110, 0
  v_mov_b32 v111, 0
  v_mov_b32 v112, 0
  v_mov_b32 v113, 0
  v_mov_b32 v114, 0
  v_mov_b32 v115, 0
  v_mov_b32 v116, 0
  v_mov_b32 v117, 0
  v_mov_b32 v118, 0
  v_mov_b32 v119, 0
  v_mov_b32 v120, 0
  v_mov_b32 v121, 0
  v_mov_b32 v122, 0
  v_mov_b32 v123, 0
  v_mov_b32 v124, 0
  v_mov_b32 v125, 0
  v_mov_b32 v126, 0
  v_mov_b32 v127, 0
  s_cmp_lg_u32 s54, 2
  s_cbranch_scc1 L_nobal
  s_getreg_b32 s72, hwreg(HW_REG_XCC_ID)
  s_and_b32 s72, s72, 7
  s_mov_b32 s75, s72
  s_lshl_b32 s76, s72, 7
  s_add_u32 s77, s76, 253952
  v_mov_b32 v60, s77
  s_mul_i32 s76, s72, 4352
  s_add_u32 s76, s76, 2097152
  v_lshl_add_u32 v61, v0, 2, s76
  s_lshl_b32 s78, s48, 12
  s_mov_b32 s79, 34
  s_mov_b32 s8, 2097152
  s_mov_b32 s24, 0
  s_mov_b32 s9, 2101504
  s_mov_b32 s25, 0
  s_mov_b32 s10, 2105856
  s_mov_b32 s26, 0
  s_mov_b32 s11, 2110208
  s_mov_b32 s27, 0
  s_mov_b32 s12, 2114560
  s_mov_b32 s28, 0
  s_mov_b32 s13, 2118912
  s_mov_b32 s29, 0
  s_mov_b32 s14, 2123264
  s_mov_b32 s30, 0
  s_mov_b32 s15, 2127616
  s_mov_b32 s31, 0
  s_lshl_b32 s72, s72, 10
  s_add_u32 s72, s72, 245760
  v_add_u32 v8, s72, v3
  s_lshl_b32 s73, s2, 2
  s_add_u32 s72, s72, s73
  v_mov_b32 v9, s72
  v_mov_b32 v6, 6160
  s_lshl_b32 s74, s48, 8
  v_lshl_add_u32 v232, v0, 2, 0
  v_and_b32 v232, 7, v232
  v_cmp_eq_u32 vcc, s7, v232
  v_mov_b32 v232, 0x10000
  v_mov_b32 v11, 0x2010000
  v_cndmask_b32 v232, v232, v11, vcc
  v_lshl_add_u32 v233, v0, 2, 1
  v_and_b32 v233, 7, v233
  v_cmp_eq_u32 vcc, s7, v233
  v_mov_b32 v233, 0x10000
  v_mov_b32 v11, 0x2010000
  v_cndmask_b32 v233, v233, v11, vcc
  v_lshl_add_u32 v234, v0, 2, 2
  v_and_b32 v234, 7, v234
  v_cmp_eq_u32 vcc, s7, v234
  v_mov_b32 v234, 0x10000
  v_mov_b32 v11, 0x2010000
  v_cndmask_b32 v234, v234, v11, vcc
  v_lshl_add_u32 v235, v0, 2, 3
  v_and_b32 v235, 7, v235
  v_cmp_eq_u32 vcc, s7, v235
  v_mov_b32 v235, 0x10000
  v_mov_b32 v11, 0x2010000
  v_cndmask_b32 v235, v235, v11, vcc
  s_mov_b32 s72, 1
  s_mov_b32 s67, 8000000
L_bk:
  s_sleep 3
  ds_read_b32 v7, v6 offset:96
  s_sub_u32 s67, s67, 1
  s_cbranch_scc1 L_nobal
  s_waitcnt lgkmcnt(0)
  v_readfirstlane_b32 s63, v7
  s_nop 0
  s_cmp_lt_u32 s63, s72
  s_cbranch_scc1 L_bk
  v_or_b32 v7, s74, v7
  s_mov_b64 exec, 1
  global_store_dword v9, v7, s[38:39]
  s_mov_b64 exec, -1
  global_load_dwordx4 v[12:15], v8, s[38:39] sc1
  global_load_dword v62, v60, s[38:39] sc1
  s_add_u32 s72, s63, 2
  v_mov_b32 v10, 0
  s_waitcnt vmcnt(0)
  v_xor_b32 v12, s74, v12
  v_cmp_gt_u32 vcc, s49, v12
  v_add_u32 v12, v232, v12
  s_nop 0
  v_cndmask_b32 v12, 0, v12, vcc
  v_add_u32 v10, v10, v12
  v_xor_b32 v13, s74, v13
  v_cmp_gt_u32 vcc, s49, v13
  v_add_u32 v13, v233, v13
  s_nop 0
  v_cndmask_b32 v13, 0, v13, vcc
  v_add_u32 v10, v10, v13
  v_xor_b32 v14, s74, v14
  v_cmp_gt_u32 vcc, s49, v14
  v_add_u32 v14, v234, v14
  s_nop 0
  v_cndmask_b32 v14, 0, v14, vcc
  v_add_u32 v10, v10, v14
  v_xor_b32 v15, s74, v15
  v_cmp_gt_u32 vcc, s49, v15
  v_add_u32 v15, v235, v15
  s_nop 0
  v_cndmask_b32 v15, 0, v15, vcc
  v_add_u32 v10, v10, v15
  s_nop 1
  v_add_u32_dpp v10, v10, v10 row_ror:8 row_mask:0xf bank_mask:0xf
  s_nop 1
  v_add_u32_dpp v10, v10, v10 row_ror:4 row_mask:0xf bank_mask:0xf
  s_nop 1
  v_add_u32_dpp v10, v10, v10 row_ror:2 row_mask:0xf bank_mask:0xf
  s_nop 1
  v_add_u32_dpp v10, v10, v10 row_ror:1 row_mask:0xf bank_mask:0xf
  v_mov_b32 v11, v10
  s_nop 1
  v_permlane16_swap_b32 v10, v11
  v_add_u32 v10, v10, v11
  v_mov_b32 v11, v10
  s_nop 1
  v_permlane32_swap_b32 v10, v11
  v_add_u32 v10, v10, v11
  v_lshrrev_b32 v11, 25, v10
  ds_write_b32 v6, v11 offset:100
  v_bfe_u32 v11, v10, 16, 9
  v_and_b32 v10, 0xffff, v10
  v_cvt_f32_u32 v11, v11
  v_cvt_f32_u32 v10, v10
  v_rcp_f32 v11, v11
  v_mul_f32 v10, 4.0, v10
  v_mul_f32 v10, v10, v11
  v_add_f32 v10, 0x41900000, v10
  v_cvt_u32_f32 v7, v10
  s_sub_u32 s64, s2, 248
  s_cmp_ge_u32 s64, 8
  s_cbranch_scc1 L_nolead
  s_load_dword s16, s[38:39], s8 glc
  s_load_dword s17, s[38:39], s9 glc
  s_load_dword s18, s[38:39], s10 glc
  s_load_dword s19, s[38:39], s11 glc
  s_load_dword s20, s[38:39], s12 glc
  s_load_dword s21, s[38:39], s13 glc
  s_load_dword s22, s[38:39], s14 glc
  s_load_dword s23, s[38:39], s15 glc
  v_readfirstlane_b32 s76, v7
  s_nop 0
  s_cmp_lt_u32 s76, s79
  s_cbranch_scc1 L_noann
  v_or_b32 v63, s78, v7
  s_mov_b32 exec_hi, 0
  global_store_dword v61, v63, s[38:39] sc1
  s_mov_b64 exec, -1
  v_add_u32 v61, 34816, v61
  s_add_u32 s79, s79, 16
L_noann:
  s_mov_b32 s64, 0
  s_mov_b32 s65, 0
  s_waitcnt lgkmcnt(0)
  s_xor_b32 s16, s16, s78
  s_sub_i32 s73, s16, s76
  s_cmp_lt_u32 s16, 0x1000
  s_cselect_b32 s24, s73, s24
  s_cselect_b32 s73, 34816, 0
  s_add_u32 s8, s8, s73
  s_add_i32 s64, s64, s24
  s_cmp_eq_u32 s75, 0
  s_cselect_b32 s65, s24, s65
  s_xor_b32 s17, s17, s78
  s_sub_i32 s73, s17, s76
  s_cmp_lt_u32 s17, 0x1000
  s_cselect_b32 s25, s73, s25
  s_cselect_b32 s73, 34816, 0
  s_add_u32 s9, s9, s73
  s_add_i32 s64, s64, s25
  s_cmp_eq_u32 s75, 1
  s_cselect_b32 s65, s25, s65
  s_xor_b32 s18, s18, s78
  s_sub_i32 s73, s18, s76
  s_cmp_lt_u32 s18, 0x1000
  s_cselect_b32 s26, s73, s26
  s_cselect_b32 s73, 34816, 0
  s_add_u32 s10, s10, s73
  s_add_i32 s64, s64, s26
  s_cmp_eq_u32 s75, 2
  s_cselect_b32 s65, s26, s65
  s_xor_b32 s19, s19, s78
  s_sub_i32 s73, s19, s76
  s_cmp_lt_u32 s19, 0x1000
  s_cselect_b32 s27, s73, s27
  s_cselect_b32 s73, 34816, 0
  s_add_u32 s11, s11, s73
  s_add_i32 s64, s64, s27
  s_cmp_eq_u32 s75, 3
  s_cselect_b32 s65, s27, s65
  s_xor_b32 s20, s20, s78
  s_sub_i32 s73, s20, s76
  s_cmp_lt_u32 s20, 0x1000
  s_cselect_b32 s28, s73, s28
  s_cselect_b32 s73, 34816, 0
  s_add_u32 s12, s12, s73
  s_add_i32 s64, s64, s28
  s_cmp_eq_u32 s75, 4
  s_cselect_b32 s65, s28, s65
  s_xor_b32 s21, s21, s78
  s_sub_i32 s73, s21, s76
  s_cmp_lt_u32 s21, 0x1000
  s_cselect_b32 s29, s73, s29
  s_cselect_b32 s73, 34816, 0
  s_add_u32 s13, s13, s73
  s_add_i32 s64, s64, s29
  s_cmp_eq_u32 s75, 5
  s_cselect_b32 s65, s29, s65
  s_xor_b32 s22, s22, s78
  s_sub_i32 s73, s22, s76
  s_cmp_lt_u32 s22, 0x1000
  s_cselect_b32 s30, s73, s30
  s_cselect_b32 s73, 34816, 0
  s_add_u32 s14, s14, s73
  s_add_i32 s64, s64, s30
  s_cmp_eq_u32 s75, 6
  s_cselect_b32 s65, s30, s65
  s_xor_b32 s23, s23, s78
  s_sub_i32 s73, s23, s76
  s_cmp_lt_u32 s23, 0x1000
  s_cselect_b32 s31, s73, s31
  s_cselect_b32 s73, 34816, 0
  s_add_u32 s15, s15, s73
  s_add_i32 s64, s64, s31
  s_cmp_eq_u32 s75, 7
  s_cselect_b32 s65, s31, s65
  s_ashr_i32 s64, s64, 3
  s_sub_i32 s64, s64, s65
  s_sub_i32 s64, s64, 3
  s_add_i32 s64, s64, 0x800
  s_and_b32 s64, s64, 0xfff
  s_or_b32 s64, s64, s78
  v_mov_b32 v63, s64
  s_mov_b64 exec, 1
  global_store_dword v60, v63, s[38:39]
  s_mov_b64 exec, -1
L_nolead:
  v_xor_b32 v62, s78, v62
  v_cmp_gt_u32 vcc, 0x1000, v62
  v_subrev_u32 v62, 0x800, v62
  s_nop 0
  v_cndmask_b32 v62, 0, v62, vcc
  v_add_u32 v7, v7, v62
  ds_write_b32 v6, v7 offset:4
  s_cmp_lt_u32 s72, 100
  s_cbranch_scc1 L_bk
L_nobal:
  s_barrier
  ds_read_b32 v33, v53 offset:88
  ds_read_b128 v[8:11], v44 offset:16896
  ds_read_b128 v[12:15], v44 offset:16960
  ds_read_b128 v[16:19], v45 offset:8192
  ds_read_b128 v[20:23], v45 offset:10304
  ds_read_b128 v[24:27], v45 offset:12416
  ds_read_b128 v[28:31], v45 offset:14528
  s_waitcnt lgkmcnt(5)
  v_readfirstlane_b32 s75, v33
  v_max3_f32 v34, v8, v9, v10
  v_max_f32 v34, v34, v11
  v_sub_f32 v8, v8, v34
  v_sub_f32 v9, v9, v34
  v_sub_f32 v10, v10, v34
  v_sub_f32 v11, v11, v34
  v_exp_f32 v8, v8
  v_exp_f32 v9, v9
  v_exp_f32 v10, v10
  v_exp_f32 v11, v11
  s_waitcnt lgkmcnt(4)
  v_mul_f32 v35, v8, v12
  v_fmac_f32 v35, v9, v13
  v_fmac_f32 v35, v10, v14
  v_fmac_f32 v35, v11, v15
  v_rcp_f32 v36, v35
  v_log_f32 v54, v35
  s_waitcnt lgkmcnt(0)
  v_mul_f32 v56, v8, v16
  v_mul_f32 v57, v8, v17
  v_mul_f32 v58, v8, v18
  v_mul_f32 v59, v8, v19
  v_fmac_f32 v56, v9, v20
  v_fmac_f32 v57, v9, v21
  v_fmac_f32 v58, v9, v22
  v_fmac_f32 v59, v9, v23
  v_fmac_f32 v56, v10, v24
  v_fmac_f32 v57, v10, v25
  v_fmac_f32 v58, v10, v26
  v_fmac_f32 v59, v10, v27
  v_fmac_f32 v56, v11, v28
  v_fmac_f32 v57, v11, v29
  v_fmac_f32 v58, v11, v30
  v_fmac_f32 v59, v11, v31
  v_add_f32 v54, v54, v34
  v_mul_f32 v56, v56, v36
  v_mul_f32 v57, v57, v36
  v_mul_f32 v58, v58, v36
  v_mul_f32 v59, v59, v36
  v_bfi_b32 v56, s49, v252, v56
  v_bfi_b32 v57, s49, v253, v57
  v_bfi_b32 v58, s49, v254, v58
  v_bfi_b32 v59, s49, v255, v59
  s_mov_b32 s71, 0
  s_cmp_lg_u32 s75, 32
  s_cbranch_scc1 L_far_st
  global_store_dwordx4 v46, v[56:59], s[38:39]
  s_mov_b32 exec_lo, 0xff
  s_mov_b32 exec_hi, 0xff
  global_store_dwordx2 v47, v[54:55], s[38:39]
  s_mov_b64 exec, -1
  s_branch L_st_done
L_far_st:
  global_store_dwordx4 v46, v[56:59], s[38:39] sc1
  s_mov_b32 exec_lo, 0xff
  s_mov_b32 exec_hi, 0xff
  global_store_dwordx2 v47, v[54:55], s[38:39] sc1
  s_mov_b64 exec, -1
L_st_done:
  buffer_load_dwordx4 v[64:67], v4, s[40:43], s56 offen offset:0 nt
  buffer_load_dwordx4 v[80:83], v4, s[40:43], s56 offen offset:1024 nt
  s_add_u32 s56, s56, 8192
  buffer_load_dwordx4 v[68:71], v4, s[40:43], s56 offen offset:0 nt
  buffer_load_dwordx4 v[84:87], v4, s[40:43], s56 offen offset:1024 nt
  s_add_u32 s56, s56, 8192
  buffer_load_dwordx4 v[72:75], v4, s[40:43], s56 offen offset:0 nt
  buffer_load_dwordx4 v[88:91], v4, s[40:43], s56 offen offset:1024 nt
  s_add_u32 s56, s56, 8192
  buffer_load_dwordx4 v[76:79], v4, s[40:43], s56 offen offset:0 nt
  buffer_load_dwordx4 v[92:95], v4, s[40:43], s56 offen offset:1024 nt
  global_load_dwordx2 v[160:161], v49, s[38:39] offset:0 sc1
  global_load_dwordx2 v[162:163], v49, s[38:39] offset:128 sc1
  global_load_dwordx2 v[164:165], v49, s[38:39] offset:256 sc1
  global_load_dwordx2 v[166:167], v49, s[38:39] offset:384 sc1
  global_load_dwordx4 v[168:171], v48, s[38:39] offset:0 sc1
  global_load_dwordx4 v[172:175], v48, s[38:39] offset:128 sc1
  global_load_dwordx4 v[176:179], v48, s[38:39] offset:256 sc1
  global_load_dwordx4 v[180:183], v48, s[38:39] offset:384 sc1
  s_waitcnt vmcnt(8)
  global_load_dwordx2 v[184:185], v49, s[38:39] offset:0 sc1
  global_load_dwordx2 v[186:187], v49, s[38:39] offset:128 sc1
  global_load_dwordx2 v[188:189], v49, s[38:39] offset:256 sc1
  global_load_dwordx2 v[190:191], v49, s[38:39] offset:384 sc1
  global_load_dwordx4 v[192:195], v48, s[38:39] offset:0 sc1
  global_load_dwordx4 v[196:199], v48, s[38:39] offset:128 sc1
  global_load_dwordx4 v[200:203], v48, s[38:39] offset:256 sc1
  global_load_dwordx4 v[204:207], v48, s[38:39] offset:384 sc1
  v_perm_b32 v128, v68, v64, s50
  v_perm_b32 v129, v76, v72, s50
  v_perm_b32 v130, v84, v80, s50
  v_perm_b32 v131, v92, v88, s50
  v_perm_b32 v132, v68, v64, s51
  v_perm_b32 v133, v76, v72, s51
  v_perm_b32 v134, v84, v80, s51
  v_perm_b32 v135, v92, v88, s51
  v_perm_b32 v136, v69, v65, s50
  v_perm_b32 v137, v77, v73, s50
  v_perm_b32 v138, v85, v81, s50
  v_perm_b32 v139, v93, v89, s50
  v_perm_b32 v140, v69, v65, s51
  v_perm_b32 v141, v77, v73, s51
  v_perm_b32 v142, v85, v81, s51
  v_perm_b32 v143, v93, v89, s51
  v_perm_b32 v144, v70, v66, s50
  v_perm_b32 v145, v78, v74, s50
  v_perm_b32 v146, v86, v82, s50
  v_perm_b32 v147, v94, v90, s50
  v_perm_b32 v148, v70, v66, s51
  v_perm_b32 v149, v78, v74, s51
  v_perm_b32 v150, v86, v82, s51
  v_perm_b32 v151, v94, v90, s51
  v_perm_b32 v152, v71, v67, s50
  v_perm_b32 v153, v79, v75, s50
  v_perm_b32 v154, v87, v83, s50
  v_perm_b32 v155, v95, v91, s50
  v_perm_b32 v156, v71, v67, s51
  v_perm_b32 v157, v79, v75, s51
  v_perm_b32 v158, v87, v83, s51
  v_perm_b32 v159, v95, v91, s51
  s_mov_b32 s67, 1000000
L_pc:
  s_waitcnt vmcnt(12)
  v_xor_b32 v5, v161, v251
  v_bitop3_b32 v5, v5, v163, v251 bitop3:0xf6
  v_bitop3_b32 v5, v5, v165, v251 bitop3:0xf6
  v_bitop3_b32 v5, v5, v167, v251 bitop3:0xf6
  v_max3_f32 v34, v160, v162, v164
  v_max_f32 v34, v34, v166
  v_sub_f32 v160, v160, v34
  v_sub_f32 v162, v162, v34
  v_sub_f32 v164, v164, v34
  v_sub_f32 v166, v166, v34
  v_exp_f32 v160, v160
  v_exp_f32 v162, v162
  v_exp_f32 v164, v164
  v_exp_f32 v166, v166
  v_add_f32 v36, v160, v162
  v_add_f32 v35, v164, v166
  v_add_f32 v36, v36, v35
  s_waitcnt vmcnt(11)
  v_xor_b32 v168, v168, v252
  v_xor_b32 v169, v169, v253
  v_xor_b32 v170, v170, v254
  v_xor_b32 v171, v171, v255
  v_or_b32 v6, v168, v169
  v_or_b32 v7, v170, v171
  v_mul_f32 v40, v160, v168
  v_mul_f32 v41, v160, v169
  v_mul_f32 v42, v160, v170
  v_mul_f32 v43, v160, v171
  s_waitcnt vmcnt(10)
  v_xor_b32 v172, v172, v252
  v_xor_b32 v173, v173, v253
  v_xor_b32 v174, v174, v254
  v_xor_b32 v175, v175, v255
  v_or3_b32 v6, v6, v172, v173
  v_or3_b32 v7, v7, v174, v175
  v_fmac_f32 v40, v162, v172
  v_fmac_f32 v41, v162, v173
  v_fmac_f32 v42, v162, v174
  v_fmac_f32 v43, v162, v175
  s_waitcnt vmcnt(9)
  v_xor_b32 v176, v176, v252
  v_xor_b32 v177, v177, v253
  v_xor_b32 v178, v178, v254
  v_xor_b32 v179, v179, v255
  v_or3_b32 v6, v6, v176, v177
  v_or3_b32 v7, v7, v178, v179
  v_fmac_f32 v40, v164, v176
  v_fmac_f32 v41, v164, v177
  v_fmac_f32 v42, v164, v178
  v_fmac_f32 v43, v164, v179
  s_waitcnt vmcnt(8)
  v_xor_b32 v180, v180, v252
  v_xor_b32 v181, v181, v253
  v_xor_b32 v182, v182, v254
  v_xor_b32 v183, v183, v255
  v_or3_b32 v6, v6, v180, v181
  v_or3_b32 v7, v7, v182, v183
  v_fmac_f32 v40, v166, v180
  v_fmac_f32 v41, v166, v181
  v_fmac_f32 v42, v166, v182
  v_fmac_f32 v43, v166, v183
  v_or_b32 v6, v6, v7
  v_and_or_b32 v6, v6, s49, v5
  v_cmp_ne_u32 vcc, 0, v6
  s_cbranch_vccz L_gc
  s_mov_b64 exec, vcc
  global_load_dwordx2 v[160:161], v49, s[38:39] offset:0 sc1
  global_load_dwordx2 v[162:163], v49, s[38:39] offset:128 sc1
  global_load_dwordx2 v[164:165], v49, s[38:39] offset:256 sc1
  global_load_dwordx2 v[166:167], v49, s[38:39] offset:384 sc1
  global_load_dwordx4 v[168:171], v48, s[38:39] offset:0 sc1
  global_load_dwordx4 v[172:175], v48, s[38:39] offset:128 sc1
  global_load_dwordx4 v[176:179], v48, s[38:39] offset:256 sc1
  global_load_dwordx4 v[180:183], v48, s[38:39] offset:384 sc1
  s_waitcnt vmcnt(12)
  v_xor_b32 v5, v185, v251
  v_bitop3_b32 v5, v5, v187, v251 bitop3:0xf6
  v_bitop3_b32 v5, v5, v189, v251 bitop3:0xf6
  v_bitop3_b32 v5, v5, v191, v251 bitop3:0xf6
  v_max3_f32 v34, v184, v186, v188
  v_max_f32 v34, v34, v190
  v_sub_f32 v184, v184, v34
  v_sub_f32 v186, v186, v34
  v_sub_f32 v188, v188, v34
  v_sub_f32 v190, v190, v34
  v_exp_f32 v184, v184
  v_exp_f32 v186, v186
  v_exp_f32 v188, v188
  v_exp_f32 v190, v190
  v_add_f32 v36, v184, v186
  v_add_f32 v35, v188, v190
  v_add_f32 v36, v36, v35
  s_waitcnt vmcnt(11)
  v_xor_b32 v192, v192, v252
  v_xor_b32 v193, v193, v253
  v_xor_b32 v194, v194, v254
  v_xor_b32 v195, v195, v255
  v_or_b32 v6, v192, v193
  v_or_b32 v7, v194, v195
  v_mul_f32 v40, v184, v192
  v_mul_f32 v41, v184, v193
  v_mul_f32 v42, v184, v194
  v_mul_f32 v43, v184, v195
  s_waitcnt vmcnt(10)
  v_xor_b32 v196, v196, v252
  v_xor_b32 v197, v197, v253
  v_xor_b32 v198, v198, v254
  v_xor_b32 v199, v199, v255
  v_or3_b32 v6, v6, v196, v197
  v_or3_b32 v7, v7, v198, v199
  v_fmac_f32 v40, v186, v196
  v_fmac_f32 v41, v186, v197
  v_fmac_f32 v42, v186, v198
  v_fmac_f32 v43, v186, v199
  s_waitcnt vmcnt(9)
  v_xor_b32 v200, v200, v252
  v_xor_b32 v201, v201, v253
  v_xor_b32 v202, v202, v254
  v_xor_b32 v203, v203, v255
  v_or3_b32 v6, v6, v200, v201
  v_or3_b32 v7, v7, v202, v203
  v_fmac_f32 v40, v188, v200
  v_fmac_f32 v41, v188, v201
  v_fmac_f32 v42, v188, v202
  v_fmac_f32 v43, v188, v203
  s_waitcnt vmcnt(8)
  v_xor_b32 v204, v204, v252
  v_xor_b32 v205, v205, v253
  v_xor_b32 v206, v206, v254
  v_xor_b32 v207, v207, v255
  v_or3_b32 v6, v6, v204, v205
  v_or3_b32 v7, v7, v206, v207
  v_fmac_f32 v40, v190, v204
  v_fmac_f32 v41, v190, v205
  v_fmac_f32 v42, v190, v206
  v_fmac_f32 v43, v190, v207
  v_or_b32 v6, v6, v7
  v_and_or_b32 v6, v6, s49, v5
  v_cmp_ne_u32 vcc, 0, v6
  s_cbranch_vccz L_gc
  s_mov_b64 exec, vcc
  global_load_dwordx2 v[184:185], v49, s[38:39] offset:0 sc1
  global_load_dwordx2 v[186:187], v49, s[38:39] offset:128 sc1
  global_load_dwordx2 v[188:189], v49, s[38:39] offset:256 sc1
  global_load_dwordx2 v[190:191], v49, s[38:39] offset:384 sc1
  global_load_dwordx4 v[192:195], v48, s[38:39] offset:0 sc1
  global_load_dwordx4 v[196:199], v48, s[38:39] offset:128 sc1
  global_load_dwordx4 v[200:203], v48, s[38:39] offset:256 sc1
  global_load_dwordx4 v[204:207], v48, s[38:39] offset:384 sc1
  s_sub_u32 s67, s67, 1
  s_cbranch_scc0 L_pc
L_gc:
  s_mov_b64 exec, -1
  ds_write_b32 v53, v53
  v_max_f32_dpp v35, v34, v34 row_ror:4 row_mask:0xf bank_mask:0xf
  s_nop 1
  v_max_f32_dpp v35, v35, v35 row_ror:8 row_mask:0xf bank_mask:0xf
  v_sub_f32 v34, v34, v35
  v_exp_f32 v34, v34
  s_nop 0
  v_mul_f32 v36, v36, v34
  v_mul_f32 v40, v40, v34
  v_mul_f32 v41, v41, v34
  v_mul_f32 v42, v42, v34
  v_mul_f32 v43, v43, v34
  v_add_f32_dpp v36, v36, v36 row_ror:4 row_mask:0xf bank_mask:0xf
  v_add_f32_dpp v40, v40, v40 row_ror:4 row_mask:0xf bank_mask:0xf
  v_add_f32_dpp v41, v41, v41 row_ror:4 row_mask:0xf bank_mask:0xf
  v_add_f32_dpp v42, v42, v42 row_ror:4 row_mask:0xf bank_mask:0xf
  v_add_f32_dpp v43, v43, v43 row_ror:4 row_mask:0xf bank_mask:0xf
  v_add_f32_dpp v36, v36, v36 row_ror:8 row_mask:0xf bank_mask:0xf
  v_add_f32_dpp v40, v40, v40 row_ror:8 row_mask:0xf bank_mask:0xf
  v_add_f32_dpp v41, v41, v41 row_ror:8 row_mask:0xf bank_mask:0xf
  v_add_f32_dpp v42, v42, v42 row_ror:8 row_mask:0xf bank_mask:0xf
  v_add_f32_dpp v43, v43, v43 row_ror:8 row_mask:0xf bank_mask:0xf
  v_rcp_f32 v36, v36
  s_nop 0
  v_mul_f32 v40, v40, v36
  v_mul_f32 v41, v41, v36
  v_mul_f32 v42, v42, v36
  v_mul_f32 v43, v43, v36
  v_cvt_pk_bf16_f32 v40, v40, v41
  v_cvt_pk_bf16_f32 v41, v42, v43
  ds_write_b64 v50, v[40:41]
  s_mov_b32 exec_lo, 0x01010101
  s_mov_b32 exec_hi, 0x01010101
  ds_read_b128 v[96:99], v51 offset:0
  s_mov_b32 exec_lo, 0x02020202
  s_mov_b32 exec_hi, 0x02020202
  ds_read_b128 v[100:103], v51 offset:0
  s_mov_b32 exec_lo, 0x04040404
  s_mov_b32 exec_hi, 0x04040404
  ds_read_b128 v[104:107], v51 offset:0
  s_mov_b32 exec_lo, 0x08080808
  s_mov_b32 exec_hi, 0x08080808
  ds_read_b128 v[108:111], v51 offset:0
  s_mov_b32 exec_lo, 0x10101010
  s_mov_b32 exec_hi, 0x10101010
  ds_read_b128 v[112:115], v51 offset:0
  s_mov_b32 exec_lo, 0x20202020
  s_mov_b32 exec_hi, 0x20202020
  ds_read_b128 v[116:119], v51 offset:0
  s_mov_b32 exec_lo, 0x40404040
  s_mov_b32 exec_hi, 0x40404040
  ds_read_b128 v[120:123], v51 offset:0
  s_mov_b32 exec_lo, 0x80808080
  s_mov_b32 exec_hi, 0x80808080
  ds_read_b128 v[124:127], v51 offset:0
  s_mov_b64 exec, -1
  s_waitcnt lgkmcnt(7)
  v_mfma_f32_16x16x32_bf16 v[16:19], v[128:131], v[96:99], 0
  s_waitcnt lgkmcnt(6)
  v_mfma_f32_16x16x32_bf16 v[16:19], v[132:135], v[100:103], v[16:19]
  s_waitcnt lgkmcnt(5)
  v_mfma_f32_16x16x32_bf16 v[16:19], v[136:139], v[104:107], v[16:19]
  s_waitcnt lgkmcnt(4)
  v_mfma_f32_16x16x32_bf16 v[16:19], v[140:143], v[108:111], v[16:19]
  s_waitcnt lgkmcnt(3)
  v_mfma_f32_16x16x32_bf16 v[16:19], v[144:147], v[112:115], v[16:19]
  s_waitcnt lgkmcnt(2)
  v_mfma_f32_16x16x32_bf16 v[16:19], v[148:151], v[116:119], v[16:19]
  s_waitcnt lgkmcnt(1)
  v_mfma_f32_16x16x32_bf16 v[16:19], v[152:155], v[120:123], v[16:19]
  s_waitcnt lgkmcnt(0)
  v_mfma_f32_16x16x32_bf16 v[16:19], v[156:159], v[124:127], v[16:19]
  s_nop 7
  v_bfi_b32 v16, s49, v252, v16
  v_bfi_b32 v17, s49, v253, v17
  v_bfi_b32 v18, s49, v254, v18
  v_bfi_b32 v19, s49, v255, v19
  global_store_dwordx4 v52, v[16:19], s[38:39] sc1
L_fin:
L_exit:
  s_endpgm
.section .rodata,"a"
.p2align 6
.amdhsa_kernel recurrent_scan__gqa_block_cached__glu_gated_geglu__decode_kernel
  .amdhsa_next_free_vgpr 256
  .amdhsa_next_free_sgpr 100
  .amdhsa_accum_offset 256
  .amdhsa_group_segment_fixed_size 0
  .amdhsa_kernarg_size 96
  .amdhsa_user_sgpr_count 2
  .amdhsa_user_sgpr_kernarg_segment_ptr 1
  .amdhsa_system_sgpr_workgroup_id_x 1
  .amdhsa_float_denorm_mode_32 3
.end_amdhsa_kernel
```
